```python
import torch

def _softmax(x, axis=-1):
    return torch.softmax(x, dim=axis)
def _gelu(x):
    return torch.nn.functional.gelu(x, approximate="tanh")
def _silu(x):
    return torch.nn.functional.silu(x)
def _sigmoid(x):
    return torch.sigmoid(x)
def _layernorm(x, axis=-1, eps=1e-5):
    m = x.mean(dim=axis, keepdim=True)
    v = x.var(dim=axis, keepdim=True, unbiased=False)
    return (x - m) / torch.sqrt(v + eps)
def _scatter_add(tgt, idx, src, axis=0):
    return tgt.clone().index_add_(axis, idx, src)
def _segment_sum(src, seg, n):
    out = torch.zeros((n,) + src.shape[1:], dtype=src.dtype)
    return out.index_add_(0, seg, src)
def _pad(x, pw):
    flat = tuple(v for pair in reversed(pw) for v in pair)
    return torch.nn.functional.pad(x, flat)

kernel_name = 'standalone__standard_2d_1d_3d_conv__vision'

def setup_inputs():

    _w = (lambda a: (lambda t: t.to(torch.bfloat16) if t.is_floating_point() else t)(torch.as_tensor(a)))
    H = W = 256
    C = 384
    K = 1
    return {
        "x": _w((lambda *s: torch.randn(*s, dtype=torch.bfloat16) * 0.05)(1, H, W, C)),
        "w": _w((lambda *s: torch.randn(*s, dtype=torch.bfloat16) * 0.05)(K, K, C, C)),
        "b": _w((lambda *s: torch.randn(*s, dtype=torch.bfloat16) * 0.05)(C)),
    }

def reference(x, w, b):
    B, H, W, Cin = x.shape
    K = w.shape[0]
    pl = (K - 1) // 2
    pr = K // 2
    xp = _pad(x, ((0, 0), (pl, pr), (pl, pr), (0, 0)))
    out = sum(
        torch.einsum('bhwc,cd->bhwd', xp[:, i:i+H, j:j+W, :], w[i, j])
        for i in range(K) for j in range(K)
    )
    return out + b[None, None, None, :]
```

```asm
; @launch grid=(256,1,1) block=(256,1,1) lds=163840
.amdgcn_target "amdgcn-amd-amdhsa--gfx950"
.text
.globl standalone__standard_2d_1d_3d_conv__vision_kernel
.p2align 8
.type standalone__standard_2d_1d_3d_conv__vision_kernel,@function
standalone__standard_2d_1d_3d_conv__vision_kernel:
    s_cmp_ge_u32 s2, 256
    s_cbranch_scc1 L_end
    s_load_dwordx4 s[36:39], s[0:1], 0
    s_load_dwordx4 s[40:43], s[0:1], 16
    v_and_b32 v1, 63, v0
    v_lshrrev_b32 v2, 6, v0
    s_nop 0
    v_readfirstlane_b32 s24, v2
    s_mul_i32 s25, s2, 196608
    s_mul_i32 s27, s24, 6144
    s_add_u32 s27, s27, 122880
    s_mul_i32 s29, s24, 6144
    s_waitcnt lgkmcnt(0)
    s_mov_b32 s8, s36
    s_and_b32 s9, s37, 0xffff
    s_mov_b32 s10, 50331648
    s_mov_b32 s11, 0x00020000
    s_mov_b32 s12, s38
    s_and_b32 s13, s39, 0xffff
    s_mov_b32 s14, 294912
    s_mov_b32 s15, 0x00020000
    s_mov_b32 s16, s40
    s_and_b32 s17, s41, 0xffff
    s_mov_b32 s18, 768
    s_mov_b32 s19, 0x00020000
    s_mov_b32 s20, s42
    s_and_b32 s21, s43, 0xffff
    s_mov_b32 s22, 50331648
    s_mov_b32 s23, 0x00020000
    s_lshr_b32 s30, s2, 3
    s_and_b32 s30, s30, 31
    s_mul_i32 s30, s30, 9216
    s_mul_i32 s31, s24, 2304
    s_add_u32 s30, s30, s31
    v_lshlrev_b32 v2, 4, v1
    buffer_load_dwordx4 v[40:43], v2, s[12:15], s30 offen offset:0
    buffer_load_dwordx4 v[44:47], v2, s[12:15], s30 offen offset:1024
    buffer_load_dwordx4 v[48:51], v2, s[12:15], s30 offen offset:1280
    s_mul_i32 s28, s24, 384
    s_movk_i32 s30, 1366
    s_movk_i32 s31, 48
    v_add_u32 v2, s28, v1
    v_mul_u32_u24 v3, s30, v2
    v_lshrrev_b32 v3, 16, v3
    v_mul_u32_u24 v4, s31, v3
    v_sub_u32 v4, v2, v4
    v_and_b32 v5, 15, v3
    v_xor_b32 v4, v4, v5
    v_lshlrev_b32 v4, 4, v4
    v_mul_u32_u24 v3, 0x300, v3
    v_add_u32 v8, v3, v4
    v_add_u32 v2, s28, v1
    v_add_u32 v2, 64, v2
    v_mul_u32_u24 v3, s30, v2
    v_lshrrev_b32 v3, 16, v3
    v_mul_u32_u24 v4, s31, v3
    v_sub_u32 v4, v2, v4
    v_and_b32 v5, 15, v3
    v_xor_b32 v4, v4, v5
    v_lshlrev_b32 v4, 4, v4
    v_mul_u32_u24 v3, 0x300, v3
    v_add_u32 v9, v3, v4
    v_add_u32 v2, s28, v1
    v_add_u32 v2, 128, v2
    v_mul_u32_u24 v3, s30, v2
    v_lshrrev_b32 v3, 16, v3
    v_mul_u32_u24 v4, s31, v3
    v_sub_u32 v4, v2, v4
    v_and_b32 v5, 15, v3
    v_xor_b32 v4, v4, v5
    v_lshlrev_b32 v4, 4, v4
    v_mul_u32_u24 v3, 0x300, v3
    v_add_u32 v10, v3, v4
    v_add_u32 v2, s28, v1
    v_add_u32 v2, 192, v2
    v_mul_u32_u24 v3, s30, v2
    v_lshrrev_b32 v3, 16, v3
    v_mul_u32_u24 v4, s31, v3
    v_sub_u32 v4, v2, v4
    v_and_b32 v5, 15, v3
    v_xor_b32 v4, v4, v5
    v_lshlrev_b32 v4, 4, v4
    v_mul_u32_u24 v3, 0x300, v3
    v_add_u32 v11, v3, v4
    v_add_u32 v2, s28, v1
    v_add_u32 v2, 256, v2
    v_mul_u32_u24 v3, s30, v2
    v_lshrrev_b32 v3, 16, v3
    v_mul_u32_u24 v4, s31, v3
    v_sub_u32 v4, v2, v4
    v_and_b32 v5, 15, v3
    v_xor_b32 v4, v4, v5
    v_lshlrev_b32 v4, 4, v4
    v_mul_u32_u24 v3, 0x300, v3
    v_add_u32 v12, v3, v4
    v_add_u32 v2, s28, v1
    v_add_u32 v2, 320, v2
    v_mul_u32_u24 v3, s30, v2
    v_lshrrev_b32 v3, 16, v3
    v_mul_u32_u24 v4, s31, v3
    v_sub_u32 v4, v2, v4
    v_and_b32 v5, 15, v3
    v_xor_b32 v4, v4, v5
    v_lshlrev_b32 v4, 4, v4
    v_mul_u32_u24 v3, 0x300, v3
    v_add_u32 v13, v3, v4
    s_add_u32 s26, s25, 0
    s_add_u32 m0, s29, 0
    s_nop 0
    buffer_load_dwordx4 v8, s[8:11], s26 offen nt lds
    s_add_u32 m0, s29, 1024
    s_nop 0
    buffer_load_dwordx4 v9, s[8:11], s26 offen nt lds
    s_add_u32 m0, s29, 2048
    s_nop 0
    buffer_load_dwordx4 v10, s[8:11], s26 offen nt lds
    s_add_u32 m0, s29, 3072
    s_nop 0
    buffer_load_dwordx4 v11, s[8:11], s26 offen nt lds
    s_add_u32 m0, s29, 4096
    s_nop 0
    buffer_load_dwordx4 v12, s[8:11], s26 offen nt lds
    s_add_u32 m0, s29, 5120
    s_nop 0
    buffer_load_dwordx4 v13, s[8:11], s26 offen nt lds
    s_add_u32 s26, s25, 24576
    s_add_u32 m0, s29, 24576
    s_nop 0
    buffer_load_dwordx4 v8, s[8:11], s26 offen nt lds
    s_add_u32 m0, s29, 25600
    s_nop 0
    buffer_load_dwordx4 v9, s[8:11], s26 offen nt lds
    s_add_u32 m0, s29, 26624
    s_nop 0
    buffer_load_dwordx4 v10, s[8:11], s26 offen nt lds
    s_add_u32 m0, s29, 27648
    s_nop 0
    buffer_load_dwordx4 v11, s[8:11], s26 offen nt lds
    s_add_u32 m0, s29, 28672
    s_nop 0
    buffer_load_dwordx4 v12, s[8:11], s26 offen nt lds
    s_add_u32 m0, s29, 29696
    s_nop 0
    buffer_load_dwordx4 v13, s[8:11], s26 offen nt lds
    s_mul_i32 s28, s24, 192
    s_movk_i32 s30, 5462
    v_mov_b32 v2, v1
    v_mul_u32_u24 v3, s30, v2
    v_lshrrev_b32 v3, 16, v3
    v_mul_u32_u24 v4, 12, v3
    v_sub_u32 v4, v2, v4
    v_lshlrev_b32 v4, 4, v4
    v_mul_u32_u24 v3, 0x300, v3
    v_add3_u32 v14, v3, v4, s28
    v_add_u32 v2, 64, v1
    v_mul_u32_u24 v3, s30, v2
    v_lshrrev_b32 v3, 16, v3
    v_mul_u32_u24 v4, 12, v3
    v_sub_u32 v4, v2, v4
    v_lshlrev_b32 v4, 4, v4
    v_mul_u32_u24 v3, 0x300, v3
    v_add3_u32 v15, v3, v4, s28
    v_add_u32 v2, 128, v1
    v_mul_u32_u24 v3, s30, v2
    v_lshrrev_b32 v3, 16, v3
    v_mul_u32_u24 v4, 12, v3
    v_sub_u32 v4, v2, v4
    v_lshlrev_b32 v4, 4, v4
    v_mul_u32_u24 v3, 0x300, v3
    v_add3_u32 v16, v3, v4, s28
    v_add_u32 v2, 192, v1
    v_mul_u32_u24 v3, s30, v2
    v_lshrrev_b32 v3, 16, v3
    v_mul_u32_u24 v4, 12, v3
    v_sub_u32 v4, v2, v4
    v_lshlrev_b32 v4, 4, v4
    v_mul_u32_u24 v3, 0x300, v3
    v_add3_u32 v17, v3, v4, s28
    v_add_u32 v2, 256, v1
    v_mul_u32_u24 v3, s30, v2
    v_lshrrev_b32 v3, 16, v3
    v_mul_u32_u24 v4, 12, v3
    v_sub_u32 v4, v2, v4
    v_lshlrev_b32 v4, 4, v4
    v_mul_u32_u24 v3, 0x300, v3
    v_add3_u32 v18, v3, v4, s28
    v_add_u32 v2, 320, v1
    v_mul_u32_u24 v3, s30, v2
    v_lshrrev_b32 v3, 16, v3
    v_mul_u32_u24 v4, 12, v3
    v_sub_u32 v4, v2, v4
    v_lshlrev_b32 v4, 4, v4
    v_mul_u32_u24 v3, 0x300, v3
    v_add3_u32 v19, v3, v4, s28
    v_lshrrev_b32 v2, 5, v1
    v_mul_u32_u24 v3, 96, v2
    v_add_u32 v39, s28, v3
    buffer_load_dwordx4 v[40:43], v39, s[16:19], 0 offen offset:0
    buffer_load_dwordx4 v[44:47], v39, s[16:19], 0 offen offset:16
    buffer_load_dwordx4 v[48:51], v39, s[16:19], 0 offen offset:32
    buffer_load_dwordx4 v[52:55], v39, s[16:19], 0 offen offset:48
    buffer_load_dwordx4 v[56:59], v39, s[16:19], 0 offen offset:64
    buffer_load_dwordx4 v[60:63], v39, s[16:19], 0 offen offset:80
    s_mul_i32 s33, s24, 16384
    s_add_u32 s33, s33, 98304
    s_mov_b32 s32, 0
    s_add_u32 m0, s33, 0
    s_nop 0
    buffer_load_dwordx4 v14, s[12:15], s32 offen lds
    s_add_u32 m0, s33, 1024
    s_nop 0
    buffer_load_dwordx4 v15, s[12:15], s32 offen lds
    s_add_u32 m0, s33, 2048
    s_nop 0
    buffer_load_dwordx4 v16, s[12:15], s32 offen lds
    s_mov_b32 s32, 12288
    s_add_u32 m0, s33, 3072
    s_nop 0
    buffer_load_dwordx4 v14, s[12:15], s32 offen lds
    s_add_u32 m0, s33, 4096
    s_nop 0
    buffer_load_dwordx4 v15, s[12:15], s32 offen lds
    s_add_u32 m0, s33, 5120
    s_nop 0
    buffer_load_dwordx4 v16, s[12:15], s32 offen lds
    s_mov_b32 s32, 24576
    s_add_u32 m0, s33, 6144
    s_nop 0
    buffer_load_dwordx4 v14, s[12:15], s32 offen lds
    s_add_u32 m0, s33, 7168
    s_nop 0
    buffer_load_dwordx4 v15, s[12:15], s32 offen lds
    s_add_u32 m0, s33, 8192
    s_nop 0
    buffer_load_dwordx4 v16, s[12:15], s32 offen lds
    s_mov_b32 s32, 36864
    s_add_u32 m0, s33, 9216
    s_nop 0
    buffer_load_dwordx4 v14, s[12:15], s32 offen lds
    s_add_u32 m0, s33, 10240
    s_nop 0
    buffer_load_dwordx4 v15, s[12:15], s32 offen lds
    s_add_u32 m0, s33, 11264
    s_nop 0
    buffer_load_dwordx4 v16, s[12:15], s32 offen lds
    s_mov_b32 s32, 49152
    s_add_u32 m0, s33, 12288
    s_nop 0
    buffer_load_dwordx4 v14, s[12:15], s32 offen lds
    s_add_u32 m0, s33, 13312
    s_nop 0
    buffer_load_dwordx4 v15, s[12:15], s32 offen lds
    s_add_u32 m0, s33, 14336
    s_nop 0
    buffer_load_dwordx4 v16, s[12:15], s32 offen lds
    s_add_u32 s26, s25, 49152
    s_add_u32 m0, s29, 49152
    s_nop 0
    buffer_load_dwordx4 v8, s[8:11], s26 offen nt lds
    s_add_u32 m0, s29, 50176
    s_nop 0
    buffer_load_dwordx4 v9, s[8:11], s26 offen nt lds
    s_add_u32 m0, s29, 51200
    s_nop 0
    buffer_load_dwordx4 v10, s[8:11], s26 offen nt lds
    s_add_u32 m0, s29, 52224
    s_nop 0
    buffer_load_dwordx4 v11, s[8:11], s26 offen nt lds
    s_add_u32 m0, s29, 53248
    s_nop 0
    buffer_load_dwordx4 v12, s[8:11], s26 offen nt lds
    s_add_u32 m0, s29, 54272
    s_nop 0
    buffer_load_dwordx4 v13, s[8:11], s26 offen nt lds
    s_add_u32 s26, s25, 73728
    s_add_u32 m0, s29, 73728
    s_nop 0
    buffer_load_dwordx4 v8, s[8:11], s26 offen nt lds
    s_add_u32 m0, s29, 74752
    s_nop 0
    buffer_load_dwordx4 v9, s[8:11], s26 offen nt lds
    s_add_u32 m0, s29, 75776
    s_nop 0
    buffer_load_dwordx4 v10, s[8:11], s26 offen nt lds
    s_add_u32 m0, s29, 76800
    s_nop 0
    buffer_load_dwordx4 v11, s[8:11], s26 offen nt lds
    s_add_u32 m0, s29, 77824
    s_nop 0
    buffer_load_dwordx4 v12, s[8:11], s26 offen nt lds
    s_add_u32 m0, s29, 78848
    s_nop 0
    buffer_load_dwordx4 v13, s[8:11], s26 offen nt lds
    v_lshlrev_b32 v37, 4, v1
    v_add_u32 v37, s27, v37
    v_and_b32 v3, 31, v1
    v_mul_u32_u24 v3, 192, v3
    v_mul_u32_u24 v4, 96, v2
    v_add3_u32 v36, v3, v4, s27
    v_bfe_u32 v3, v1, 2, 2
    v_lshl_add_u32 v3, v2, 3, v3
    v_mul_u32_u24 v3, 192, v3
    v_and_b32 v4, 1, v1
    v_mul_u32_u24 v4, 96, v4
    v_add_u32 v3, v3, v4
    v_bfe_u32 v4, v1, 1, 1
    v_bfe_u32 v5, v1, 4, 1
    v_lshl_add_u32 v4, v5, 1, v4
    v_lshlrev_b32 v4, 3, v4
    v_add3_u32 v38, v3, v4, s33
    v_and_b32 v3, 31, v1
    v_and_b32 v4, 15, v1
    v_xor_b32 v4, v4, v2
    v_lshlrev_b32 v4, 4, v4
    v_mul_u32_u24 v3, 0x300, v3
    v_add_u32 v20, v3, v4
    v_xor_b32 v21, 32, v20
    v_xor_b32 v22, 64, v20
    v_xor_b32 v23, 96, v20
    v_xor_b32 v24, 128, v20
    v_xor_b32 v25, 160, v20
    v_xor_b32 v26, 192, v20
    v_xor_b32 v27, 224, v20
    s_waitcnt vmcnt(27)
    v_lshlrev_b32 v176, 16, v40
    v_and_b32 v177, 0xffff0000, v40
    v_lshlrev_b32 v178, 16, v41
    v_and_b32 v179, 0xffff0000, v41
    v_lshlrev_b32 v180, 16, v42
    v_and_b32 v181, 0xffff0000, v42
    v_lshlrev_b32 v182, 16, v43
    v_and_b32 v183, 0xffff0000, v43
    v_lshlrev_b32 v184, 16, v44
    v_and_b32 v185, 0xffff0000, v44
    v_lshlrev_b32 v186, 16, v45
    v_and_b32 v187, 0xffff0000, v45
    v_lshlrev_b32 v188, 16, v46
    v_and_b32 v189, 0xffff0000, v46
    v_lshlrev_b32 v190, 16, v47
    v_and_b32 v191, 0xffff0000, v47
    v_lshlrev_b32 v192, 16, v48
    v_and_b32 v193, 0xffff0000, v48
    v_lshlrev_b32 v194, 16, v49
    v_and_b32 v195, 0xffff0000, v49
    v_lshlrev_b32 v196, 16, v50
    v_and_b32 v197, 0xffff0000, v50
    v_lshlrev_b32 v198, 16, v51
    v_and_b32 v199, 0xffff0000, v51
    v_lshlrev_b32 v200, 16, v52
    v_and_b32 v201, 0xffff0000, v52
    v_lshlrev_b32 v202, 16, v53
    v_and_b32 v203, 0xffff0000, v53
    v_lshlrev_b32 v204, 16, v54
    v_and_b32 v205, 0xffff0000, v54
    v_lshlrev_b32 v206, 16, v55
    v_and_b32 v207, 0xffff0000, v55
    v_lshlrev_b32 v208, 16, v56
    v_and_b32 v209, 0xffff0000, v56
    v_lshlrev_b32 v210, 16, v57
    v_and_b32 v211, 0xffff0000, v57
    v_lshlrev_b32 v212, 16, v58
    v_and_b32 v213, 0xffff0000, v58
    v_lshlrev_b32 v214, 16, v59
    v_and_b32 v215, 0xffff0000, v59
    v_lshlrev_b32 v216, 16, v60
    v_and_b32 v217, 0xffff0000, v60
    v_lshlrev_b32 v218, 16, v61
    v_and_b32 v219, 0xffff0000, v61
    v_lshlrev_b32 v220, 16, v62
    v_and_b32 v221, 0xffff0000, v62
    v_lshlrev_b32 v222, 16, v63
    v_and_b32 v223, 0xffff0000, v63
    s_waitcnt vmcnt(33)
    s_barrier
    v_add_u32 v28, 24576, v20
    v_add_u32 v29, 24576, v21
    v_add_u32 v30, 24576, v22
    v_add_u32 v31, 24576, v23
    v_add_u32 v32, 24576, v24
    v_add_u32 v33, 24576, v25
    v_add_u32 v34, 24576, v26
    v_add_u32 v35, 24576, v27
    s_waitcnt vmcnt(24)
    ds_read_b64_tr_b16 a[0:1], v38 offset:0
    ds_read_b64_tr_b16 a[2:3], v38 offset:768
    ds_read_b64_tr_b16 a[4:5], v38 offset:32
    ds_read_b64_tr_b16 a[6:7], v38 offset:800
    ds_read_b64_tr_b16 a[8:9], v38 offset:64
    ds_read_b64_tr_b16 a[10:11], v38 offset:832
    ds_read_b128 v[64:67], v20 offset:0
    ds_read_b128 v[68:71], v28 offset:0
    s_waitcnt lgkmcnt(0)
    s_mov_b32 s32, 61440
    s_add_u32 m0, s33, 0
    s_nop 0
    buffer_load_dwordx4 v14, s[12:15], s32 offen lds
    s_add_u32 m0, s33, 1024
    s_nop 0
    buffer_load_dwordx4 v15, s[12:15], s32 offen lds
    s_add_u32 m0, s33, 2048
    s_nop 0
    buffer_load_dwordx4 v16, s[12:15], s32 offen lds
    ds_read_b128 v[72:75], v21 offset:0
    ds_read_b128 v[76:79], v29 offset:0
    v_mfma_f32_32x32x16_bf16 v[80:95], a[0:3], v[64:67], v[176:191]
    v_mfma_f32_32x32x16_bf16 v[96:111], a[4:7], v[64:67], v[192:207]
    v_mfma_f32_32x32x16_bf16 v[112:127], a[8:11], v[64:67], v[208:223]
    s_waitcnt vmcnt(24)
    ds_read_b64_tr_b16 a[12:13], v38 offset:3072
    ds_read_b64_tr_b16 a[14:15], v38 offset:3840
    ds_read_b64_tr_b16 a[16:17], v38 offset:3104
    ds_read_b64_tr_b16 a[18:19], v38 offset:3872
    ds_read_b64_tr_b16 a[20:21], v38 offset:3136
    ds_read_b64_tr_b16 a[22:23], v38 offset:3904
    v_mfma_f32_32x32x16_bf16 v[128:143], a[0:3], v[68:71], v[176:191]
    v_mfma_f32_32x32x16_bf16 v[144:159], a[4:7], v[68:71], v[192:207]
    v_mfma_f32_32x32x16_bf16 v[160:175], a[8:11], v[68:71], v[208:223]
    s_waitcnt lgkmcnt(0)
    s_mov_b32 s32, 73728
    s_add_u32 m0, s33, 3072
    s_nop 0
    buffer_load_dwordx4 v14, s[12:15], s32 offen lds
    s_add_u32 m0, s33, 4096
    s_nop 0
    buffer_load_dwordx4 v15, s[12:15], s32 offen lds
    s_add_u32 m0, s33, 5120
    s_nop 0
    buffer_load_dwordx4 v16, s[12:15], s32 offen lds
    ds_read_b128 v[64:67], v22 offset:0
    ds_read_b128 v[68:71], v30 offset:0
    v_mfma_f32_32x32x16_bf16 v[80:95], a[12:15], v[72:75], v[80:95]
    v_mfma_f32_32x32x16_bf16 v[96:111], a[16:19], v[72:75], v[96:111]
    v_mfma_f32_32x32x16_bf16 v[112:127], a[20:23], v[72:75], v[112:127]
    s_waitcnt vmcnt(24)
    ds_read_b64_tr_b16 a[24:25], v38 offset:6144
    ds_read_b64_tr_b16 a[26:27], v38 offset:6912
    ds_read_b64_tr_b16 a[28:29], v38 offset:6176
    ds_read_b64_tr_b16 a[30:31], v38 offset:6944
    ds_read_b64_tr_b16 a[32:33], v38 offset:6208
    ds_read_b64_tr_b16 a[34:35], v38 offset:6976
    v_mfma_f32_32x32x16_bf16 v[128:143], a[12:15], v[76:79], v[128:143]
    v_mfma_f32_32x32x16_bf16 v[144:159], a[16:19], v[76:79], v[144:159]
    v_mfma_f32_32x32x16_bf16 v[160:175], a[20:23], v[76:79], v[160:175]
    s_waitcnt lgkmcnt(0)
    s_mov_b32 s32, 86016
    s_add_u32 m0, s33, 6144
    s_nop 0
    buffer_load_dwordx4 v14, s[12:15], s32 offen lds
    s_add_u32 m0, s33, 7168
    s_nop 0
    buffer_load_dwordx4 v15, s[12:15], s32 offen lds
    s_add_u32 m0, s33, 8192
    s_nop 0
    buffer_load_dwordx4 v16, s[12:15], s32 offen lds
    ds_read_b128 v[72:75], v23 offset:0
    ds_read_b128 v[76:79], v31 offset:0
    v_mfma_f32_32x32x16_bf16 v[80:95], a[24:27], v[64:67], v[80:95]
    v_mfma_f32_32x32x16_bf16 v[96:111], a[28:31], v[64:67], v[96:111]
    v_mfma_f32_32x32x16_bf16 v[112:127], a[32:35], v[64:67], v[112:127]
    s_waitcnt vmcnt(24)
    ds_read_b64_tr_b16 a[36:37], v38 offset:9216
    ds_read_b64_tr_b16 a[38:39], v38 offset:9984
    ds_read_b64_tr_b16 a[40:41], v38 offset:9248
    ds_read_b64_tr_b16 a[42:43], v38 offset:10016
    ds_read_b64_tr_b16 a[44:45], v38 offset:9280
    ds_read_b64_tr_b16 a[46:47], v38 offset:10048
    v_mfma_f32_32x32x16_bf16 v[128:143], a[24:27], v[68:71], v[128:143]
    v_mfma_f32_32x32x16_bf16 v[144:159], a[28:31], v[68:71], v[144:159]
    v_mfma_f32_32x32x16_bf16 v[160:175], a[32:35], v[68:71], v[160:175]
    s_waitcnt lgkmcnt(0)
    s_mov_b32 s32, 98304
    s_add_u32 m0, s33, 9216
    s_nop 0
    buffer_load_dwordx4 v14, s[12:15], s32 offen lds
    s_add_u32 m0, s33, 10240
    s_nop 0
    buffer_load_dwordx4 v15, s[12:15], s32 offen lds
    s_add_u32 m0, s33, 11264
    s_nop 0
    buffer_load_dwordx4 v16, s[12:15], s32 offen lds
    ds_read_b128 v[64:67], v24 offset:0
    ds_read_b128 v[68:71], v32 offset:0
    v_mfma_f32_32x32x16_bf16 v[80:95], a[36:39], v[72:75], v[80:95]
    v_mfma_f32_32x32x16_bf16 v[96:111], a[40:43], v[72:75], v[96:111]
    v_mfma_f32_32x32x16_bf16 v[112:127], a[44:47], v[72:75], v[112:127]
    s_waitcnt vmcnt(24)
    ds_read_b64_tr_b16 a[48:49], v38 offset:12288
    ds_read_b64_tr_b16 a[50:51], v38 offset:13056
    ds_read_b64_tr_b16 a[52:53], v38 offset:12320
    ds_read_b64_tr_b16 a[54:55], v38 offset:13088
    ds_read_b64_tr_b16 a[56:57], v38 offset:12352
    ds_read_b64_tr_b16 a[58:59], v38 offset:13120
    v_mfma_f32_32x32x16_bf16 v[128:143], a[36:39], v[76:79], v[128:143]
    v_mfma_f32_32x32x16_bf16 v[144:159], a[40:43], v[76:79], v[144:159]
    v_mfma_f32_32x32x16_bf16 v[160:175], a[44:47], v[76:79], v[160:175]
    s_waitcnt lgkmcnt(0)
    s_mov_b32 s32, 110592
    s_add_u32 m0, s33, 12288
    s_nop 0
    buffer_load_dwordx4 v14, s[12:15], s32 offen lds
    s_add_u32 m0, s33, 13312
    s_nop 0
    buffer_load_dwordx4 v15, s[12:15], s32 offen lds
    s_add_u32 m0, s33, 14336
    s_nop 0
    buffer_load_dwordx4 v16, s[12:15], s32 offen lds
    ds_read_b128 v[72:75], v25 offset:0
    ds_read_b128 v[76:79], v33 offset:0
    v_mfma_f32_32x32x16_bf16 v[80:95], a[48:51], v[64:67], v[80:95]
    v_mfma_f32_32x32x16_bf16 v[96:111], a[52:55], v[64:67], v[96:111]
    v_mfma_f32_32x32x16_bf16 v[112:127], a[56:59], v[64:67], v[112:127]
    s_waitcnt vmcnt(12)
    ds_read_b64_tr_b16 a[60:61], v38 offset:0
    ds_read_b64_tr_b16 a[62:63], v38 offset:768
    ds_read_b64_tr_b16 a[64:65], v38 offset:32
    ds_read_b64_tr_b16 a[66:67], v38 offset:800
    ds_read_b64_tr_b16 a[68:69], v38 offset:64
    ds_read_b64_tr_b16 a[70:71], v38 offset:832
    v_mfma_f32_32x32x16_bf16 v[128:143], a[48:51], v[68:71], v[128:143]
    v_mfma_f32_32x32x16_bf16 v[144:159], a[52:55], v[68:71], v[144:159]
    v_mfma_f32_32x32x16_bf16 v[160:175], a[56:59], v[68:71], v[160:175]
    s_waitcnt lgkmcnt(0)
    s_mov_b32 s32, 122880
    s_add_u32 m0, s33, 0
    s_nop 0
    buffer_load_dwordx4 v14, s[12:15], s32 offen lds
    s_add_u32 m0, s33, 1024
    s_nop 0
    buffer_load_dwordx4 v15, s[12:15], s32 offen lds
    s_add_u32 m0, s33, 2048
    s_nop 0
    buffer_load_dwordx4 v16, s[12:15], s32 offen lds
    ds_read_b128 v[64:67], v26 offset:0
    ds_read_b128 v[68:71], v34 offset:0
    v_mfma_f32_32x32x16_bf16 v[80:95], a[60:63], v[72:75], v[80:95]
    v_mfma_f32_32x32x16_bf16 v[96:111], a[64:67], v[72:75], v[96:111]
    v_mfma_f32_32x32x16_bf16 v[112:127], a[68:71], v[72:75], v[112:127]
    s_waitcnt vmcnt(12)
    ds_read_b64_tr_b16 a[72:73], v38 offset:3072
    ds_read_b64_tr_b16 a[74:75], v38 offset:3840
    ds_read_b64_tr_b16 a[76:77], v38 offset:3104
    ds_read_b64_tr_b16 a[78:79], v38 offset:3872
    ds_read_b64_tr_b16 a[80:81], v38 offset:3136
    ds_read_b64_tr_b16 a[82:83], v38 offset:3904
    v_mfma_f32_32x32x16_bf16 v[128:143], a[60:63], v[76:79], v[128:143]
    v_mfma_f32_32x32x16_bf16 v[144:159], a[64:67], v[76:79], v[144:159]
    v_mfma_f32_32x32x16_bf16 v[160:175], a[68:71], v[76:79], v[160:175]
    s_waitcnt lgkmcnt(0)
    s_mov_b32 s32, 135168
    s_add_u32 m0, s33, 3072
    s_nop 0
    buffer_load_dwordx4 v14, s[12:15], s32 offen lds
    s_add_u32 m0, s33, 4096
    s_nop 0
    buffer_load_dwordx4 v15, s[12:15], s32 offen lds
    s_add_u32 m0, s33, 5120
    s_nop 0
    buffer_load_dwordx4 v16, s[12:15], s32 offen lds
    ds_read_b128 v[72:75], v27 offset:0
    ds_read_b128 v[76:79], v35 offset:0
    v_mfma_f32_32x32x16_bf16 v[80:95], a[72:75], v[64:67], v[80:95]
    v_mfma_f32_32x32x16_bf16 v[96:111], a[76:79], v[64:67], v[96:111]
    v_mfma_f32_32x32x16_bf16 v[112:127], a[80:83], v[64:67], v[112:127]
    s_waitcnt vmcnt(12)
    ds_read_b64_tr_b16 a[84:85], v38 offset:6144
    ds_read_b64_tr_b16 a[86:87], v38 offset:6912
    ds_read_b64_tr_b16 a[88:89], v38 offset:6176
    ds_read_b64_tr_b16 a[90:91], v38 offset:6944
    ds_read_b64_tr_b16 a[92:93], v38 offset:6208
    ds_read_b64_tr_b16 a[94:95], v38 offset:6976
    v_mfma_f32_32x32x16_bf16 v[128:143], a[72:75], v[68:71], v[128:143]
    v_mfma_f32_32x32x16_bf16 v[144:159], a[76:79], v[68:71], v[144:159]
    v_mfma_f32_32x32x16_bf16 v[160:175], a[80:83], v[68:71], v[160:175]
    s_waitcnt lgkmcnt(0)
    s_mov_b32 s32, 147456
    s_add_u32 m0, s33, 6144
    s_nop 0
    buffer_load_dwordx4 v14, s[12:15], s32 offen lds
    s_add_u32 m0, s33, 7168
    s_nop 0
    buffer_load_dwordx4 v15, s[12:15], s32 offen lds
    s_add_u32 m0, s33, 8192
    s_nop 0
    buffer_load_dwordx4 v16, s[12:15], s32 offen lds
    ds_read_b128 v[64:67], v20 offset:256
    ds_read_b128 v[68:71], v28 offset:256
    v_mfma_f32_32x32x16_bf16 v[80:95], a[84:87], v[72:75], v[80:95]
    v_mfma_f32_32x32x16_bf16 v[96:111], a[88:91], v[72:75], v[96:111]
    v_mfma_f32_32x32x16_bf16 v[112:127], a[92:95], v[72:75], v[112:127]
    s_waitcnt vmcnt(12)
    ds_read_b64_tr_b16 a[96:97], v38 offset:9216
    ds_read_b64_tr_b16 a[98:99], v38 offset:9984
    ds_read_b64_tr_b16 a[100:101], v38 offset:9248
    ds_read_b64_tr_b16 a[102:103], v38 offset:10016
    ds_read_b64_tr_b16 a[104:105], v38 offset:9280
    ds_read_b64_tr_b16 a[106:107], v38 offset:10048
    v_mfma_f32_32x32x16_bf16 v[128:143], a[84:87], v[76:79], v[128:143]
    v_mfma_f32_32x32x16_bf16 v[144:159], a[88:91], v[76:79], v[144:159]
    v_mfma_f32_32x32x16_bf16 v[160:175], a[92:95], v[76:79], v[160:175]
    s_waitcnt lgkmcnt(0)
    s_mov_b32 s32, 159744
    s_add_u32 m0, s33, 9216
    s_nop 0
    buffer_load_dwordx4 v14, s[12:15], s32 offen lds
    s_add_u32 m0, s33, 10240
    s_nop 0
    buffer_load_dwordx4 v15, s[12:15], s32 offen lds
    s_add_u32 m0, s33, 11264
    s_nop 0
    buffer_load_dwordx4 v16, s[12:15], s32 offen lds
    ds_read_b128 v[72:75], v21 offset:256
    ds_read_b128 v[76:79], v29 offset:256
    v_mfma_f32_32x32x16_bf16 v[80:95], a[96:99], v[64:67], v[80:95]
    v_mfma_f32_32x32x16_bf16 v[96:111], a[100:103], v[64:67], v[96:111]
    v_mfma_f32_32x32x16_bf16 v[112:127], a[104:107], v[64:67], v[112:127]
    s_waitcnt vmcnt(12)
    ds_read_b64_tr_b16 a[108:109], v38 offset:12288
    ds_read_b64_tr_b16 a[110:111], v38 offset:13056
    ds_read_b64_tr_b16 a[112:113], v38 offset:12320
    ds_read_b64_tr_b16 a[114:115], v38 offset:13088
    ds_read_b64_tr_b16 a[116:117], v38 offset:12352
    ds_read_b64_tr_b16 a[118:119], v38 offset:13120
    v_mfma_f32_32x32x16_bf16 v[128:143], a[96:99], v[68:71], v[128:143]
    v_mfma_f32_32x32x16_bf16 v[144:159], a[100:103], v[68:71], v[144:159]
    v_mfma_f32_32x32x16_bf16 v[160:175], a[104:107], v[68:71], v[160:175]
    s_waitcnt lgkmcnt(0)
    s_mov_b32 s32, 172032
    s_add_u32 m0, s33, 12288
    s_nop 0
    buffer_load_dwordx4 v14, s[12:15], s32 offen lds
    s_add_u32 m0, s33, 13312
    s_nop 0
    buffer_load_dwordx4 v15, s[12:15], s32 offen lds
    s_add_u32 m0, s33, 14336
    s_nop 0
    buffer_load_dwordx4 v16, s[12:15], s32 offen lds
    ds_read_b128 v[64:67], v22 offset:256
    ds_read_b128 v[68:71], v30 offset:256
    v_mfma_f32_32x32x16_bf16 v[80:95], a[108:111], v[72:75], v[80:95]
    v_mfma_f32_32x32x16_bf16 v[96:111], a[112:115], v[72:75], v[96:111]
    v_mfma_f32_32x32x16_bf16 v[112:127], a[116:119], v[72:75], v[112:127]
    s_waitcnt vmcnt(12)
    ds_read_b64_tr_b16 a[120:121], v38 offset:0
    ds_read_b64_tr_b16 a[122:123], v38 offset:768
    ds_read_b64_tr_b16 a[124:125], v38 offset:32
    ds_read_b64_tr_b16 a[126:127], v38 offset:800
    ds_read_b64_tr_b16 a[128:129], v38 offset:64
    ds_read_b64_tr_b16 a[130:131], v38 offset:832
    v_mfma_f32_32x32x16_bf16 v[128:143], a[108:111], v[76:79], v[128:143]
    v_mfma_f32_32x32x16_bf16 v[144:159], a[112:115], v[76:79], v[144:159]
    v_mfma_f32_32x32x16_bf16 v[160:175], a[116:119], v[76:79], v[160:175]
    s_waitcnt lgkmcnt(0)
    s_mov_b32 s32, 184320
    s_add_u32 m0, s33, 0
    s_nop 0
    buffer_load_dwordx4 v14, s[12:15], s32 offen lds
    s_add_u32 m0, s33, 1024
    s_nop 0
    buffer_load_dwordx4 v15, s[12:15], s32 offen lds
    s_add_u32 m0, s33, 2048
    s_nop 0
    buffer_load_dwordx4 v16, s[12:15], s32 offen lds
    ds_read_b128 v[72:75], v23 offset:256
    ds_read_b128 v[76:79], v31 offset:256
    v_mfma_f32_32x32x16_bf16 v[80:95], a[120:123], v[64:67], v[80:95]
    v_mfma_f32_32x32x16_bf16 v[96:111], a[124:127], v[64:67], v[96:111]
    v_mfma_f32_32x32x16_bf16 v[112:127], a[128:131], v[64:67], v[112:127]
    s_waitcnt vmcnt(12)
    ds_read_b64_tr_b16 a[132:133], v38 offset:3072
    ds_read_b64_tr_b16 a[134:135], v38 offset:3840
    ds_read_b64_tr_b16 a[136:137], v38 offset:3104
    ds_read_b64_tr_b16 a[138:139], v38 offset:3872
    ds_read_b64_tr_b16 a[140:141], v38 offset:3136
    ds_read_b64_tr_b16 a[142:143], v38 offset:3904
    v_mfma_f32_32x32x16_bf16 v[128:143], a[120:123], v[68:71], v[128:143]
    v_mfma_f32_32x32x16_bf16 v[144:159], a[124:127], v[68:71], v[144:159]
    v_mfma_f32_32x32x16_bf16 v[160:175], a[128:131], v[68:71], v[160:175]
    s_waitcnt lgkmcnt(0)
    s_mov_b32 s32, 196608
    s_add_u32 m0, s33, 3072
    s_nop 0
    buffer_load_dwordx4 v14, s[12:15], s32 offen lds
    s_add_u32 m0, s33, 4096
    s_nop 0
    buffer_load_dwordx4 v15, s[12:15], s32 offen lds
    s_add_u32 m0, s33, 5120
    s_nop 0
    buffer_load_dwordx4 v16, s[12:15], s32 offen lds
    ds_read_b128 v[64:67], v24 offset:256
    ds_read_b128 v[68:71], v32 offset:256
    v_mfma_f32_32x32x16_bf16 v[80:95], a[132:135], v[72:75], v[80:95]
    v_mfma_f32_32x32x16_bf16 v[96:111], a[136:139], v[72:75], v[96:111]
    v_mfma_f32_32x32x16_bf16 v[112:127], a[140:143], v[72:75], v[112:127]
    s_waitcnt vmcnt(12)
    ds_read_b64_tr_b16 a[144:145], v38 offset:6144
    ds_read_b64_tr_b16 a[146:147], v38 offset:6912
    ds_read_b64_tr_b16 a[148:149], v38 offset:6176
    ds_read_b64_tr_b16 a[150:151], v38 offset:6944
    ds_read_b64_tr_b16 a[152:153], v38 offset:6208
    ds_read_b64_tr_b16 a[154:155], v38 offset:6976
    v_mfma_f32_32x32x16_bf16 v[128:143], a[132:135], v[76:79], v[128:143]
    v_mfma_f32_32x32x16_bf16 v[144:159], a[136:139], v[76:79], v[144:159]
    v_mfma_f32_32x32x16_bf16 v[160:175], a[140:143], v[76:79], v[160:175]
    s_waitcnt lgkmcnt(0)
    s_mov_b32 s32, 208896
    s_add_u32 m0, s33, 6144
    s_nop 0
    buffer_load_dwordx4 v14, s[12:15], s32 offen lds
    s_add_u32 m0, s33, 7168
    s_nop 0
    buffer_load_dwordx4 v15, s[12:15], s32 offen lds
    s_add_u32 m0, s33, 8192
    s_nop 0
    buffer_load_dwordx4 v16, s[12:15], s32 offen lds
    ds_read_b128 v[72:75], v25 offset:256
    ds_read_b128 v[76:79], v33 offset:256
    v_mfma_f32_32x32x16_bf16 v[80:95], a[144:147], v[64:67], v[80:95]
    v_mfma_f32_32x32x16_bf16 v[96:111], a[148:151], v[64:67], v[96:111]
    v_mfma_f32_32x32x16_bf16 v[112:127], a[152:155], v[64:67], v[112:127]
    s_waitcnt vmcnt(12)
    ds_read_b64_tr_b16 a[156:157], v38 offset:9216
    ds_read_b64_tr_b16 a[158:159], v38 offset:9984
    ds_read_b64_tr_b16 a[160:161], v38 offset:9248
    ds_read_b64_tr_b16 a[162:163], v38 offset:10016
    ds_read_b64_tr_b16 a[164:165], v38 offset:9280
    ds_read_b64_tr_b16 a[166:167], v38 offset:10048
    v_mfma_f32_32x32x16_bf16 v[128:143], a[144:147], v[68:71], v[128:143]
    v_mfma_f32_32x32x16_bf16 v[144:159], a[148:151], v[68:71], v[144:159]
    v_mfma_f32_32x32x16_bf16 v[160:175], a[152:155], v[68:71], v[160:175]
    s_waitcnt lgkmcnt(0)
    s_mov_b32 s32, 221184
    s_add_u32 m0, s33, 9216
    s_nop 0
    buffer_load_dwordx4 v14, s[12:15], s32 offen lds
    s_add_u32 m0, s33, 10240
    s_nop 0
    buffer_load_dwordx4 v15, s[12:15], s32 offen lds
    s_add_u32 m0, s33, 11264
    s_nop 0
    buffer_load_dwordx4 v16, s[12:15], s32 offen lds
    ds_read_b128 v[64:67], v26 offset:256
    ds_read_b128 v[68:71], v34 offset:256
    v_mfma_f32_32x32x16_bf16 v[80:95], a[156:159], v[72:75], v[80:95]
    v_mfma_f32_32x32x16_bf16 v[96:111], a[160:163], v[72:75], v[96:111]
    v_mfma_f32_32x32x16_bf16 v[112:127], a[164:167], v[72:75], v[112:127]
    s_waitcnt vmcnt(12)
    ds_read_b64_tr_b16 a[168:169], v38 offset:12288
    ds_read_b64_tr_b16 a[170:171], v38 offset:13056
    ds_read_b64_tr_b16 a[172:173], v38 offset:12320
    ds_read_b64_tr_b16 a[174:175], v38 offset:13088
    ds_read_b64_tr_b16 a[176:177], v38 offset:12352
    ds_read_b64_tr_b16 a[178:179], v38 offset:13120
    v_mfma_f32_32x32x16_bf16 v[128:143], a[156:159], v[76:79], v[128:143]
    v_mfma_f32_32x32x16_bf16 v[144:159], a[160:163], v[76:79], v[144:159]
    v_mfma_f32_32x32x16_bf16 v[160:175], a[164:167], v[76:79], v[160:175]
    s_waitcnt lgkmcnt(0)
    s_mov_b32 s32, 233472
    s_add_u32 m0, s33, 12288
    s_nop 0
    buffer_load_dwordx4 v14, s[12:15], s32 offen lds
    s_add_u32 m0, s33, 13312
    s_nop 0
    buffer_load_dwordx4 v15, s[12:15], s32 offen lds
    s_add_u32 m0, s33, 14336
    s_nop 0
    buffer_load_dwordx4 v16, s[12:15], s32 offen lds
    ds_read_b128 v[72:75], v27 offset:256
    ds_read_b128 v[76:79], v35 offset:256
    v_mfma_f32_32x32x16_bf16 v[80:95], a[168:171], v[64:67], v[80:95]
    v_mfma_f32_32x32x16_bf16 v[96:111], a[172:175], v[64:67], v[96:111]
    v_mfma_f32_32x32x16_bf16 v[112:127], a[176:179], v[64:67], v[112:127]
    s_waitcnt vmcnt(12)
    ds_read_b64_tr_b16 a[180:181], v38 offset:0
    ds_read_b64_tr_b16 a[182:183], v38 offset:768
    ds_read_b64_tr_b16 a[184:185], v38 offset:32
    ds_read_b64_tr_b16 a[186:187], v38 offset:800
    ds_read_b64_tr_b16 a[188:189], v38 offset:64
    ds_read_b64_tr_b16 a[190:191], v38 offset:832
    v_mfma_f32_32x32x16_bf16 v[128:143], a[168:171], v[68:71], v[128:143]
    v_mfma_f32_32x32x16_bf16 v[144:159], a[172:175], v[68:71], v[144:159]
    v_mfma_f32_32x32x16_bf16 v[160:175], a[176:179], v[68:71], v[160:175]
    s_waitcnt lgkmcnt(0)
    s_mov_b32 s32, 245760
    s_add_u32 m0, s33, 0
    s_nop 0
    buffer_load_dwordx4 v14, s[12:15], s32 offen lds
    s_add_u32 m0, s33, 1024
    s_nop 0
    buffer_load_dwordx4 v15, s[12:15], s32 offen lds
    s_add_u32 m0, s33, 2048
    s_nop 0
    buffer_load_dwordx4 v16, s[12:15], s32 offen lds
    ds_read_b128 v[64:67], v20 offset:512
    ds_read_b128 v[68:71], v28 offset:512
    v_mfma_f32_32x32x16_bf16 v[80:95], a[180:183], v[72:75], v[80:95]
    v_mfma_f32_32x32x16_bf16 v[96:111], a[184:187], v[72:75], v[96:111]
    v_mfma_f32_32x32x16_bf16 v[112:127], a[188:191], v[72:75], v[112:127]
    s_waitcnt vmcnt(12)
    ds_read_b64_tr_b16 a[192:193], v38 offset:3072
    ds_read_b64_tr_b16 a[194:195], v38 offset:3840
    ds_read_b64_tr_b16 a[196:197], v38 offset:3104
    ds_read_b64_tr_b16 a[198:199], v38 offset:3872
    ds_read_b64_tr_b16 a[200:201], v38 offset:3136
    ds_read_b64_tr_b16 a[202:203], v38 offset:3904
    v_mfma_f32_32x32x16_bf16 v[128:143], a[180:183], v[76:79], v[128:143]
    v_mfma_f32_32x32x16_bf16 v[144:159], a[184:187], v[76:79], v[144:159]
    v_mfma_f32_32x32x16_bf16 v[160:175], a[188:191], v[76:79], v[160:175]
    s_waitcnt lgkmcnt(0)
    s_mov_b32 s32, 258048
    s_add_u32 m0, s33, 3072
    s_nop 0
    buffer_load_dwordx4 v14, s[12:15], s32 offen lds
    s_add_u32 m0, s33, 4096
    s_nop 0
    buffer_load_dwordx4 v15, s[12:15], s32 offen lds
    s_add_u32 m0, s33, 5120
    s_nop 0
    buffer_load_dwordx4 v16, s[12:15], s32 offen lds
    ds_read_b128 v[72:75], v21 offset:512
    ds_read_b128 v[76:79], v29 offset:512
    v_mfma_f32_32x32x16_bf16 v[80:95], a[192:195], v[64:67], v[80:95]
    v_mfma_f32_32x32x16_bf16 v[96:111], a[196:199], v[64:67], v[96:111]
    v_mfma_f32_32x32x16_bf16 v[112:127], a[200:203], v[64:67], v[112:127]
    s_waitcnt vmcnt(12)
    ds_read_b64_tr_b16 a[204:205], v38 offset:6144
    ds_read_b64_tr_b16 a[206:207], v38 offset:6912
    ds_read_b64_tr_b16 a[208:209], v38 offset:6176
    ds_read_b64_tr_b16 a[210:211], v38 offset:6944
    ds_read_b64_tr_b16 a[212:213], v38 offset:6208
    ds_read_b64_tr_b16 a[214:215], v38 offset:6976
    v_mfma_f32_32x32x16_bf16 v[128:143], a[192:195], v[68:71], v[128:143]
    v_mfma_f32_32x32x16_bf16 v[144:159], a[196:199], v[68:71], v[144:159]
    v_mfma_f32_32x32x16_bf16 v[160:175], a[200:203], v[68:71], v[160:175]
    s_waitcnt lgkmcnt(0)
    s_mov_b32 s32, 270336
    s_add_u32 m0, s33, 6144
    s_nop 0
    buffer_load_dwordx4 v14, s[12:15], s32 offen lds
    s_add_u32 m0, s33, 7168
    s_nop 0
    buffer_load_dwordx4 v15, s[12:15], s32 offen lds
    s_add_u32 m0, s33, 8192
    s_nop 0
    buffer_load_dwordx4 v16, s[12:15], s32 offen lds
    ds_read_b128 v[64:67], v22 offset:512
    ds_read_b128 v[68:71], v30 offset:512
    v_mfma_f32_32x32x16_bf16 v[80:95], a[204:207], v[72:75], v[80:95]
    v_mfma_f32_32x32x16_bf16 v[96:111], a[208:211], v[72:75], v[96:111]
    v_mfma_f32_32x32x16_bf16 v[112:127], a[212:215], v[72:75], v[112:127]
    s_waitcnt vmcnt(12)
    ds_read_b64_tr_b16 a[216:217], v38 offset:9216
    ds_read_b64_tr_b16 a[218:219], v38 offset:9984
    ds_read_b64_tr_b16 a[220:221], v38 offset:9248
    ds_read_b64_tr_b16 a[222:223], v38 offset:10016
    ds_read_b64_tr_b16 a[224:225], v38 offset:9280
    ds_read_b64_tr_b16 a[226:227], v38 offset:10048
    v_mfma_f32_32x32x16_bf16 v[128:143], a[204:207], v[76:79], v[128:143]
    v_mfma_f32_32x32x16_bf16 v[144:159], a[208:211], v[76:79], v[144:159]
    v_mfma_f32_32x32x16_bf16 v[160:175], a[212:215], v[76:79], v[160:175]
    s_waitcnt lgkmcnt(0)
    s_mov_b32 s32, 282624
    s_add_u32 m0, s33, 9216
    s_nop 0
    buffer_load_dwordx4 v14, s[12:15], s32 offen lds
    s_add_u32 m0, s33, 10240
    s_nop 0
    buffer_load_dwordx4 v15, s[12:15], s32 offen lds
    s_add_u32 m0, s33, 11264
    s_nop 0
    buffer_load_dwordx4 v16, s[12:15], s32 offen lds
    ds_read_b128 v[72:75], v23 offset:512
    ds_read_b128 v[76:79], v31 offset:512
    v_mfma_f32_32x32x16_bf16 v[80:95], a[216:219], v[64:67], v[80:95]
    v_mfma_f32_32x32x16_bf16 v[96:111], a[220:223], v[64:67], v[96:111]
    v_mfma_f32_32x32x16_bf16 v[112:127], a[224:227], v[64:67], v[112:127]
    s_waitcnt vmcnt(12)
    ds_read_b64_tr_b16 a[228:229], v38 offset:12288
    ds_read_b64_tr_b16 a[230:231], v38 offset:13056
    ds_read_b64_tr_b16 a[232:233], v38 offset:12320
    ds_read_b64_tr_b16 a[234:235], v38 offset:13088
    ds_read_b64_tr_b16 a[236:237], v38 offset:12352
    ds_read_b64_tr_b16 a[238:239], v38 offset:13120
    v_mfma_f32_32x32x16_bf16 v[128:143], a[216:219], v[68:71], v[128:143]
    v_mfma_f32_32x32x16_bf16 v[144:159], a[220:223], v[68:71], v[144:159]
    v_mfma_f32_32x32x16_bf16 v[160:175], a[224:227], v[68:71], v[160:175]
    s_waitcnt lgkmcnt(0)
    ds_read_b128 v[64:67], v24 offset:512
    ds_read_b128 v[68:71], v32 offset:512
    v_mfma_f32_32x32x16_bf16 v[80:95], a[228:231], v[72:75], v[80:95]
    v_mfma_f32_32x32x16_bf16 v[96:111], a[232:235], v[72:75], v[96:111]
    v_mfma_f32_32x32x16_bf16 v[112:127], a[236:239], v[72:75], v[112:127]
    s_waitcnt vmcnt(9)
    ds_read_b64_tr_b16 a[240:241], v38 offset:0
    ds_read_b64_tr_b16 a[242:243], v38 offset:768
    ds_read_b64_tr_b16 a[244:245], v38 offset:32
    ds_read_b64_tr_b16 a[246:247], v38 offset:800
    ds_read_b64_tr_b16 a[248:249], v38 offset:64
    ds_read_b64_tr_b16 a[250:251], v38 offset:832
    v_mfma_f32_32x32x16_bf16 v[128:143], a[228:231], v[76:79], v[128:143]
    v_mfma_f32_32x32x16_bf16 v[144:159], a[232:235], v[76:79], v[144:159]
    v_mfma_f32_32x32x16_bf16 v[160:175], a[236:239], v[76:79], v[160:175]
    s_waitcnt lgkmcnt(0)
    ds_read_b128 v[72:75], v25 offset:512
    ds_read_b128 v[76:79], v33 offset:512
    v_mfma_f32_32x32x16_bf16 v[80:95], a[240:243], v[64:67], v[80:95]
    v_mfma_f32_32x32x16_bf16 v[96:111], a[244:247], v[64:67], v[96:111]
    v_mfma_f32_32x32x16_bf16 v[112:127], a[248:251], v[64:67], v[112:127]
    s_waitcnt vmcnt(6)
    ds_read_b64_tr_b16 a[252:253], v38 offset:3072
    ds_read_b64_tr_b16 a[254:255], v38 offset:3840
    ds_read_b64_tr_b16 v[224:225], v38 offset:3104
    ds_read_b64_tr_b16 v[226:227], v38 offset:3872
    ds_read_b64_tr_b16 v[228:229], v38 offset:3136
    ds_read_b64_tr_b16 v[230:231], v38 offset:3904
    v_mfma_f32_32x32x16_bf16 v[128:143], a[240:243], v[68:71], v[128:143]
    v_mfma_f32_32x32x16_bf16 v[144:159], a[244:247], v[68:71], v[144:159]
    v_mfma_f32_32x32x16_bf16 v[160:175], a[248:251], v[68:71], v[160:175]
    s_waitcnt lgkmcnt(0)
    ds_read_b128 v[64:67], v26 offset:512
    ds_read_b128 v[68:71], v34 offset:512
    v_mfma_f32_32x32x16_bf16 v[80:95], a[252:255], v[72:75], v[80:95]
    v_mfma_f32_32x32x16_bf16 v[96:111], v[224:227], v[72:75], v[96:111]
    v_mfma_f32_32x32x16_bf16 v[112:127], v[228:231], v[72:75], v[112:127]
    s_waitcnt vmcnt(3)
    ds_read_b64_tr_b16 v[232:233], v38 offset:6144
    ds_read_b64_tr_b16 v[234:235], v38 offset:6912
    ds_read_b64_tr_b16 v[236:237], v38 offset:6176
    ds_read_b64_tr_b16 v[238:239], v38 offset:6944
    ds_read_b64_tr_b16 v[240:241], v38 offset:6208
    ds_read_b64_tr_b16 v[242:243], v38 offset:6976
    v_mfma_f32_32x32x16_bf16 v[128:143], a[252:255], v[76:79], v[128:143]
    v_mfma_f32_32x32x16_bf16 v[144:159], v[224:227], v[76:79], v[144:159]
    v_mfma_f32_32x32x16_bf16 v[160:175], v[228:231], v[76:79], v[160:175]
    s_waitcnt lgkmcnt(0)
    ds_read_b128 v[72:75], v27 offset:512
    ds_read_b128 v[76:79], v35 offset:512
    v_mfma_f32_32x32x16_bf16 v[80:95], v[232:235], v[64:67], v[80:95]
    v_mfma_f32_32x32x16_bf16 v[96:111], v[236:239], v[64:67], v[96:111]
    v_mfma_f32_32x32x16_bf16 v[112:127], v[240:243], v[64:67], v[112:127]
    s_waitcnt vmcnt(0)
    ds_read_b64_tr_b16 v[244:245], v38 offset:9216
    ds_read_b64_tr_b16 v[246:247], v38 offset:9984
    ds_read_b64_tr_b16 v[248:249], v38 offset:9248
    ds_read_b64_tr_b16 v[250:251], v38 offset:10016
    ds_read_b64_tr_b16 v[252:253], v38 offset:9280
    ds_read_b64_tr_b16 v[254:255], v38 offset:10048
    v_mfma_f32_32x32x16_bf16 v[128:143], v[232:235], v[68:71], v[128:143]
    v_mfma_f32_32x32x16_bf16 v[144:159], v[236:239], v[68:71], v[144:159]
    v_mfma_f32_32x32x16_bf16 v[160:175], v[240:243], v[68:71], v[160:175]
    s_waitcnt lgkmcnt(0)
    v_mfma_f32_32x32x16_bf16 v[80:95], v[244:247], v[72:75], v[80:95]
    v_mfma_f32_32x32x16_bf16 v[96:111], v[248:251], v[72:75], v[96:111]
    v_mfma_f32_32x32x16_bf16 v[112:127], v[252:255], v[72:75], v[112:127]
    v_mfma_f32_32x32x16_bf16 v[128:143], v[244:247], v[76:79], v[128:143]
    v_mfma_f32_32x32x16_bf16 v[144:159], v[248:251], v[76:79], v[144:159]
    v_mfma_f32_32x32x16_bf16 v[160:175], v[252:255], v[76:79], v[160:175]
    s_nop 15
    s_barrier
    s_add_u32 s26, s25, 98304
    s_add_u32 m0, s29, 98304
    s_nop 0
    buffer_load_dwordx4 v8, s[8:11], s26 offen nt lds
    s_add_u32 m0, s29, 99328
    s_nop 0
    buffer_load_dwordx4 v9, s[8:11], s26 offen nt lds
    s_add_u32 m0, s29, 100352
    s_nop 0
    buffer_load_dwordx4 v10, s[8:11], s26 offen nt lds
    s_add_u32 m0, s29, 101376
    s_nop 0
    buffer_load_dwordx4 v11, s[8:11], s26 offen nt lds
    s_add_u32 m0, s29, 102400
    s_nop 0
    buffer_load_dwordx4 v12, s[8:11], s26 offen nt lds
    s_add_u32 m0, s29, 103424
    s_nop 0
    buffer_load_dwordx4 v13, s[8:11], s26 offen nt lds
    s_add_u32 s26, s25, 122880
    s_add_u32 m0, s29, 0
    s_nop 0
    buffer_load_dwordx4 v8, s[8:11], s26 offen nt lds
    s_add_u32 m0, s29, 1024
    s_nop 0
    buffer_load_dwordx4 v9, s[8:11], s26 offen nt lds
    s_add_u32 m0, s29, 2048
    s_nop 0
    buffer_load_dwordx4 v10, s[8:11], s26 offen nt lds
    s_add_u32 m0, s29, 3072
    s_nop 0
    buffer_load_dwordx4 v11, s[8:11], s26 offen nt lds
    s_add_u32 m0, s29, 4096
    s_nop 0
    buffer_load_dwordx4 v12, s[8:11], s26 offen nt lds
    s_add_u32 m0, s29, 5120
    s_nop 0
    buffer_load_dwordx4 v13, s[8:11], s26 offen nt lds
    s_add_u32 s26, s25, 147456
    s_add_u32 m0, s29, 24576
    s_nop 0
    buffer_load_dwordx4 v8, s[8:11], s26 offen nt lds
    s_add_u32 m0, s29, 25600
    s_nop 0
    buffer_load_dwordx4 v9, s[8:11], s26 offen nt lds
    s_add_u32 m0, s29, 26624
    s_nop 0
    buffer_load_dwordx4 v10, s[8:11], s26 offen nt lds
    s_add_u32 m0, s29, 27648
    s_nop 0
    buffer_load_dwordx4 v11, s[8:11], s26 offen nt lds
    s_add_u32 m0, s29, 28672
    s_nop 0
    buffer_load_dwordx4 v12, s[8:11], s26 offen nt lds
    s_add_u32 m0, s29, 29696
    s_nop 0
    buffer_load_dwordx4 v13, s[8:11], s26 offen nt lds
    v_cvt_pk_bf16_f32 v40, v80, v81
    v_cvt_pk_bf16_f32 v41, v82, v83
    v_cvt_pk_bf16_f32 v42, v84, v85
    v_cvt_pk_bf16_f32 v43, v86, v87
    ds_write_b128 v36, v[40:43] offset:0
    v_cvt_pk_bf16_f32 v44, v88, v89
    v_cvt_pk_bf16_f32 v45, v90, v91
    v_cvt_pk_bf16_f32 v46, v92, v93
    v_cvt_pk_bf16_f32 v47, v94, v95
    ds_write_b128 v36, v[44:47] offset:16
    v_cvt_pk_bf16_f32 v48, v96, v97
    v_cvt_pk_bf16_f32 v49, v98, v99
    v_cvt_pk_bf16_f32 v50, v100, v101
    v_cvt_pk_bf16_f32 v51, v102, v103
    ds_write_b128 v36, v[48:51] offset:32
    v_cvt_pk_bf16_f32 v52, v104, v105
    v_cvt_pk_bf16_f32 v53, v106, v107
    v_cvt_pk_bf16_f32 v54, v108, v109
    v_cvt_pk_bf16_f32 v55, v110, v111
    ds_write_b128 v36, v[52:55] offset:48
    v_cvt_pk_bf16_f32 v56, v112, v113
    v_cvt_pk_bf16_f32 v57, v114, v115
    v_cvt_pk_bf16_f32 v58, v116, v117
    v_cvt_pk_bf16_f32 v59, v118, v119
    ds_write_b128 v36, v[56:59] offset:64
    v_cvt_pk_bf16_f32 v60, v120, v121
    v_cvt_pk_bf16_f32 v61, v122, v123
    v_cvt_pk_bf16_f32 v62, v124, v125
    v_cvt_pk_bf16_f32 v63, v126, v127
    ds_write_b128 v36, v[60:63] offset:80
    ds_read_b128 v[40:43], v37 offset:0
    ds_read_b128 v[44:47], v37 offset:1024
    ds_read_b128 v[48:51], v37 offset:2048
    ds_read_b128 v[52:55], v37 offset:3072
    ds_read_b128 v[56:59], v37 offset:4096
    ds_read_b128 v[60:63], v37 offset:5120
    s_add_u32 s32, s25, 0
    s_waitcnt lgkmcnt(5)
    buffer_store_dwordx4 v[40:43], v14, s[20:23], s32 offen nt
    s_waitcnt lgkmcnt(4)
    buffer_store_dwordx4 v[44:47], v15, s[20:23], s32 offen nt
    s_waitcnt lgkmcnt(3)
    buffer_store_dwordx4 v[48:51], v16, s[20:23], s32 offen nt
    s_waitcnt lgkmcnt(2)
    buffer_store_dwordx4 v[52:55], v17, s[20:23], s32 offen nt
    s_waitcnt lgkmcnt(1)
    buffer_store_dwordx4 v[56:59], v18, s[20:23], s32 offen nt
    s_waitcnt lgkmcnt(0)
    buffer_store_dwordx4 v[60:63], v19, s[20:23], s32 offen nt
    s_waitcnt vmcnt(63)
    s_barrier
    v_add_u32 v28, 49152, v20
    v_add_u32 v29, 49152, v21
    v_add_u32 v30, 49152, v22
    v_add_u32 v31, 49152, v23
    v_add_u32 v32, 49152, v24
    v_add_u32 v33, 49152, v25
    v_add_u32 v34, 49152, v26
    v_add_u32 v35, 49152, v27
    ds_read_b128 v[64:67], v28 offset:0
    ds_read_b128 v[68:71], v29 offset:0
    ds_read_b128 v[72:75], v30 offset:0
    s_waitcnt lgkmcnt(2)
    v_mfma_f32_32x32x16_bf16 v[80:95], a[0:3], v[64:67], v[176:191]
    ds_read_b128 v[76:79], v31 offset:0
    v_mfma_f32_32x32x16_bf16 v[96:111], a[4:7], v[64:67], v[192:207]
    v_mfma_f32_32x32x16_bf16 v[112:127], a[8:11], v[64:67], v[208:223]
    s_waitcnt lgkmcnt(2)
    v_mfma_f32_32x32x16_bf16 v[80:95], a[12:15], v[68:71], v[80:95]
    ds_read_b128 v[64:67], v32 offset:0
    v_mfma_f32_32x32x16_bf16 v[96:111], a[16:19], v[68:71], v[96:111]
    v_mfma_f32_32x32x16_bf16 v[112:127], a[20:23], v[68:71], v[112:127]
    v_cvt_pk_bf16_f32 v40, v128, v129
    v_cvt_pk_bf16_f32 v41, v130, v131
    v_cvt_pk_bf16_f32 v42, v132, v133
    v_cvt_pk_bf16_f32 v43, v134, v135
    ds_write_b128 v36, v[40:43] offset:0
    s_waitcnt lgkmcnt(3)
    v_mfma_f32_32x32x16_bf16 v[80:95], a[24:27], v[72:75], v[80:95]
    ds_read_b128 v[68:71], v33 offset:0
    v_mfma_f32_32x32x16_bf16 v[96:111], a[28:31], v[72:75], v[96:111]
    v_mfma_f32_32x32x16_bf16 v[112:127], a[32:35], v[72:75], v[112:127]
    v_cvt_pk_bf16_f32 v44, v136, v137
    v_cvt_pk_bf16_f32 v45, v138, v139
    v_cvt_pk_bf16_f32 v46, v140, v141
    v_cvt_pk_bf16_f32 v47, v142, v143
    ds_write_b128 v36, v[44:47] offset:16
    s_waitcnt lgkmcnt(4)
    v_mfma_f32_32x32x16_bf16 v[80:95], a[36:39], v[76:79], v[80:95]
    ds_read_b128 v[72:75], v34 offset:0
    v_mfma_f32_32x32x16_bf16 v[96:111], a[40:43], v[76:79], v[96:111]
    v_mfma_f32_32x32x16_bf16 v[112:127], a[44:47], v[76:79], v[112:127]
    v_cvt_pk_bf16_f32 v48, v144, v145
    v_cvt_pk_bf16_f32 v49, v146, v147
    v_cvt_pk_bf16_f32 v50, v148, v149
    v_cvt_pk_bf16_f32 v51, v150, v151
    ds_write_b128 v36, v[48:51] offset:32
    s_waitcnt lgkmcnt(5)
    v_mfma_f32_32x32x16_bf16 v[80:95], a[48:51], v[64:67], v[80:95]
    ds_read_b128 v[76:79], v35 offset:0
    v_mfma_f32_32x32x16_bf16 v[96:111], a[52:55], v[64:67], v[96:111]
    v_mfma_f32_32x32x16_bf16 v[112:127], a[56:59], v[64:67], v[112:127]
    v_cvt_pk_bf16_f32 v52, v152, v153
    v_cvt_pk_bf16_f32 v53, v154, v155
    v_cvt_pk_bf16_f32 v54, v156, v157
    v_cvt_pk_bf16_f32 v55, v158, v159
    ds_write_b128 v36, v[52:55] offset:48
    s_waitcnt lgkmcnt(5)
    v_mfma_f32_32x32x16_bf16 v[80:95], a[60:63], v[68:71], v[80:95]
    ds_read_b128 v[64:67], v28 offset:256
    v_mfma_f32_32x32x16_bf16 v[96:111], a[64:67], v[68:71], v[96:111]
    v_mfma_f32_32x32x16_bf16 v[112:127], a[68:71], v[68:71], v[112:127]
    v_cvt_pk_bf16_f32 v56, v160, v161
    v_cvt_pk_bf16_f32 v57, v162, v163
    v_cvt_pk_bf16_f32 v58, v164, v165
    v_cvt_pk_bf16_f32 v59, v166, v167
    ds_write_b128 v36, v[56:59] offset:64
    s_waitcnt lgkmcnt(5)
    v_mfma_f32_32x32x16_bf16 v[80:95], a[72:75], v[72:75], v[80:95]
    ds_read_b128 v[68:71], v29 offset:256
    v_mfma_f32_32x32x16_bf16 v[96:111], a[76:79], v[72:75], v[96:111]
    v_mfma_f32_32x32x16_bf16 v[112:127], a[80:83], v[72:75], v[112:127]
    v_cvt_pk_bf16_f32 v60, v168, v169
    v_cvt_pk_bf16_f32 v61, v170, v171
    v_cvt_pk_bf16_f32 v62, v172, v173
    v_cvt_pk_bf16_f32 v63, v174, v175
    ds_write_b128 v36, v[60:63] offset:80
    s_waitcnt lgkmcnt(5)
    v_mfma_f32_32x32x16_bf16 v[80:95], a[84:87], v[76:79], v[80:95]
    ds_read_b128 v[72:75], v30 offset:256
    v_mfma_f32_32x32x16_bf16 v[96:111], a[88:91], v[76:79], v[96:111]
    v_mfma_f32_32x32x16_bf16 v[112:127], a[92:95], v[76:79], v[112:127]
    ds_read_b128 v[40:43], v37 offset:0
    s_waitcnt lgkmcnt(5)
    v_mfma_f32_32x32x16_bf16 v[80:95], a[96:99], v[64:67], v[80:95]
    ds_read_b128 v[76:79], v31 offset:256
    v_mfma_f32_32x32x16_bf16 v[96:111], a[100:103], v[64:67], v[96:111]
    v_mfma_f32_32x32x16_bf16 v[112:127], a[104:107], v[64:67], v[112:127]
    ds_read_b128 v[44:47], v37 offset:1024
    s_waitcnt lgkmcnt(5)
    v_mfma_f32_32x32x16_bf16 v[80:95], a[108:111], v[68:71], v[80:95]
    ds_read_b128 v[64:67], v32 offset:256
    v_mfma_f32_32x32x16_bf16 v[96:111], a[112:115], v[68:71], v[96:111]
    v_mfma_f32_32x32x16_bf16 v[112:127], a[116:119], v[68:71], v[112:127]
    ds_read_b128 v[48:51], v37 offset:2048
    s_waitcnt lgkmcnt(5)
    v_mfma_f32_32x32x16_bf16 v[80:95], a[120:123], v[72:75], v[80:95]
    ds_read_b128 v[68:71], v33 offset:256
    v_mfma_f32_32x32x16_bf16 v[96:111], a[124:127], v[72:75], v[96:111]
    v_mfma_f32_32x32x16_bf16 v[112:127], a[128:131], v[72:75], v[112:127]
    ds_read_b128 v[52:55], v37 offset:3072
    s_waitcnt lgkmcnt(5)
    v_mfma_f32_32x32x16_bf16 v[80:95], a[132:135], v[76:79], v[80:95]
    ds_read_b128 v[72:75], v34 offset:256
    v_mfma_f32_32x32x16_bf16 v[96:111], a[136:139], v[76:79], v[96:111]
    v_mfma_f32_32x32x16_bf16 v[112:127], a[140:143], v[76:79], v[112:127]
    ds_read_b128 v[56:59], v37 offset:4096
    s_waitcnt lgkmcnt(5)
    v_mfma_f32_32x32x16_bf16 v[80:95], a[144:147], v[64:67], v[80:95]
    ds_read_b128 v[76:79], v35 offset:256
    v_mfma_f32_32x32x16_bf16 v[96:111], a[148:151], v[64:67], v[96:111]
    v_mfma_f32_32x32x16_bf16 v[112:127], a[152:155], v[64:67], v[112:127]
    ds_read_b128 v[60:63], v37 offset:5120
    s_waitcnt lgkmcnt(5)
    v_mfma_f32_32x32x16_bf16 v[80:95], a[156:159], v[68:71], v[80:95]
    ds_read_b128 v[64:67], v28 offset:512
    v_mfma_f32_32x32x16_bf16 v[96:111], a[160:163], v[68:71], v[96:111]
    v_mfma_f32_32x32x16_bf16 v[112:127], a[164:167], v[68:71], v[112:127]
    s_add_u32 s32, s25, 24576
    s_waitcnt lgkmcnt(11)
    buffer_store_dwordx4 v[40:43], v14, s[20:23], s32 offen nt
    s_waitcnt lgkmcnt(4)
    v_mfma_f32_32x32x16_bf16 v[80:95], a[168:171], v[72:75], v[80:95]
    ds_read_b128 v[68:71], v29 offset:512
    v_mfma_f32_32x32x16_bf16 v[96:111], a[172:175], v[72:75], v[96:111]
    v_mfma_f32_32x32x16_bf16 v[112:127], a[176:179], v[72:75], v[112:127]
    s_waitcnt lgkmcnt(10)
    buffer_store_dwordx4 v[44:47], v15, s[20:23], s32 offen nt
    s_waitcnt lgkmcnt(3)
    v_mfma_f32_32x32x16_bf16 v[80:95], a[180:183], v[76:79], v[80:95]
    ds_read_b128 v[72:75], v30 offset:512
    v_mfma_f32_32x32x16_bf16 v[96:111], a[184:187], v[76:79], v[96:111]
    v_mfma_f32_32x32x16_bf16 v[112:127], a[188:191], v[76:79], v[112:127]
    s_waitcnt lgkmcnt(9)
    buffer_store_dwordx4 v[48:51], v16, s[20:23], s32 offen nt
    s_waitcnt lgkmcnt(2)
    v_mfma_f32_32x32x16_bf16 v[80:95], a[192:195], v[64:67], v[80:95]
    ds_read_b128 v[76:79], v31 offset:512
    v_mfma_f32_32x32x16_bf16 v[96:111], a[196:199], v[64:67], v[96:111]
    v_mfma_f32_32x32x16_bf16 v[112:127], a[200:203], v[64:67], v[112:127]
    s_waitcnt lgkmcnt(8)
    buffer_store_dwordx4 v[52:55], v17, s[20:23], s32 offen nt
    s_waitcnt lgkmcnt(2)
    v_mfma_f32_32x32x16_bf16 v[80:95], a[204:207], v[68:71], v[80:95]
    ds_read_b128 v[64:67], v32 offset:512
    v_mfma_f32_32x32x16_bf16 v[96:111], a[208:211], v[68:71], v[96:111]
    v_mfma_f32_32x32x16_bf16 v[112:127], a[212:215], v[68:71], v[112:127]
    s_waitcnt lgkmcnt(7)
    buffer_store_dwordx4 v[56:59], v18, s[20:23], s32 offen nt
    s_waitcnt lgkmcnt(2)
    v_mfma_f32_32x32x16_bf16 v[80:95], a[216:219], v[72:75], v[80:95]
    ds_read_b128 v[68:71], v33 offset:512
    v_mfma_f32_32x32x16_bf16 v[96:111], a[220:223], v[72:75], v[96:111]
    v_mfma_f32_32x32x16_bf16 v[112:127], a[224:227], v[72:75], v[112:127]
    s_waitcnt lgkmcnt(6)
    buffer_store_dwordx4 v[60:63], v19, s[20:23], s32 offen nt
    s_waitcnt lgkmcnt(2)
    v_mfma_f32_32x32x16_bf16 v[80:95], a[228:231], v[76:79], v[80:95]
    ds_read_b128 v[72:75], v34 offset:512
    v_mfma_f32_32x32x16_bf16 v[96:111], a[232:235], v[76:79], v[96:111]
    v_mfma_f32_32x32x16_bf16 v[112:127], a[236:239], v[76:79], v[112:127]
    s_waitcnt lgkmcnt(2)
    v_mfma_f32_32x32x16_bf16 v[80:95], a[240:243], v[64:67], v[80:95]
    ds_read_b128 v[76:79], v35 offset:512
    v_mfma_f32_32x32x16_bf16 v[96:111], a[244:247], v[64:67], v[96:111]
    v_mfma_f32_32x32x16_bf16 v[112:127], a[248:251], v[64:67], v[112:127]
    s_waitcnt lgkmcnt(2)
    v_mfma_f32_32x32x16_bf16 v[80:95], a[252:255], v[68:71], v[80:95]
    v_mfma_f32_32x32x16_bf16 v[96:111], v[224:227], v[68:71], v[96:111]
    v_mfma_f32_32x32x16_bf16 v[112:127], v[228:231], v[68:71], v[112:127]
    s_waitcnt lgkmcnt(1)
    v_mfma_f32_32x32x16_bf16 v[80:95], v[232:235], v[72:75], v[80:95]
    v_mfma_f32_32x32x16_bf16 v[96:111], v[236:239], v[72:75], v[96:111]
    v_mfma_f32_32x32x16_bf16 v[112:127], v[240:243], v[72:75], v[112:127]
    s_waitcnt lgkmcnt(0)
    v_mfma_f32_32x32x16_bf16 v[80:95], v[244:247], v[76:79], v[80:95]
    v_mfma_f32_32x32x16_bf16 v[96:111], v[248:251], v[76:79], v[96:111]
    v_mfma_f32_32x32x16_bf16 v[112:127], v[252:255], v[76:79], v[112:127]
    s_waitcnt vmcnt(63)
    s_barrier
    v_add_u32 v28, 73728, v20
    v_add_u32 v29, 73728, v21
    v_add_u32 v30, 73728, v22
    v_add_u32 v31, 73728, v23
    v_add_u32 v32, 73728, v24
    v_add_u32 v33, 73728, v25
    v_add_u32 v34, 73728, v26
    v_add_u32 v35, 73728, v27
    ds_read_b128 v[64:67], v28 offset:0
    ds_read_b128 v[68:71], v29 offset:0
    ds_read_b128 v[72:75], v30 offset:0
    s_waitcnt lgkmcnt(2)
    v_mfma_f32_32x32x16_bf16 v[128:143], a[0:3], v[64:67], v[176:191]
    ds_read_b128 v[76:79], v31 offset:0
    v_mfma_f32_32x32x16_bf16 v[144:159], a[4:7], v[64:67], v[192:207]
    s_add_u32 s26, s25, 172032
    s_add_u32 m0, s29, 49152
    s_nop 0
    buffer_load_dwordx4 v8, s[8:11], s26 offen nt lds
    v_mfma_f32_32x32x16_bf16 v[160:175], a[8:11], v[64:67], v[208:223]
    s_waitcnt lgkmcnt(2)
    v_mfma_f32_32x32x16_bf16 v[128:143], a[12:15], v[68:71], v[128:143]
    ds_read_b128 v[64:67], v32 offset:0
    v_mfma_f32_32x32x16_bf16 v[144:159], a[16:19], v[68:71], v[144:159]
    s_add_u32 m0, s29, 50176
    s_nop 0
    buffer_load_dwordx4 v9, s[8:11], s26 offen nt lds
    v_mfma_f32_32x32x16_bf16 v[160:175], a[20:23], v[68:71], v[160:175]
    v_cvt_pk_bf16_f32 v40, v80, v81
    v_cvt_pk_bf16_f32 v41, v82, v83
    v_cvt_pk_bf16_f32 v42, v84, v85
    v_cvt_pk_bf16_f32 v43, v86, v87
    ds_write_b128 v36, v[40:43] offset:0
    s_waitcnt lgkmcnt(3)
    v_mfma_f32_32x32x16_bf16 v[128:143], a[24:27], v[72:75], v[128:143]
    ds_read_b128 v[68:71], v33 offset:0
    v_mfma_f32_32x32x16_bf16 v[144:159], a[28:31], v[72:75], v[144:159]
    s_add_u32 m0, s29, 51200
    s_nop 0
    buffer_load_dwordx4 v10, s[8:11], s26 offen nt lds
    v_mfma_f32_32x32x16_bf16 v[160:175], a[32:35], v[72:75], v[160:175]
    v_cvt_pk_bf16_f32 v44, v88, v89
    v_cvt_pk_bf16_f32 v45, v90, v91
    v_cvt_pk_bf16_f32 v46, v92, v93
    v_cvt_pk_bf16_f32 v47, v94, v95
    ds_write_b128 v36, v[44:47] offset:16
    s_waitcnt lgkmcnt(4)
    v_mfma_f32_32x32x16_bf16 v[128:143], a[36:39], v[76:79], v[128:143]
    ds_read_b128 v[72:75], v34 offset:0
    v_mfma_f32_32x32x16_bf16 v[144:159], a[40:43], v[76:79], v[144:159]
    s_add_u32 m0, s29, 52224
    s_nop 0
    buffer_load_dwordx4 v11, s[8:11], s26 offen nt lds
    v_mfma_f32_32x32x16_bf16 v[160:175], a[44:47], v[76:79], v[160:175]
    v_cvt_pk_bf16_f32 v48, v96, v97
    v_cvt_pk_bf16_f32 v49, v98, v99
    v_cvt_pk_bf16_f32 v50, v100, v101
    v_cvt_pk_bf16_f32 v51, v102, v103
    ds_write_b128 v36, v[48:51] offset:32
    s_waitcnt lgkmcnt(5)
    v_mfma_f32_32x32x16_bf16 v[128:143], a[48:51], v[64:67], v[128:143]
    ds_read_b128 v[76:79], v35 offset:0
    v_mfma_f32_32x32x16_bf16 v[144:159], a[52:55], v[64:67], v[144:159]
    s_add_u32 m0, s29, 53248
    s_nop 0
    buffer_load_dwordx4 v12, s[8:11], s26 offen nt lds
    v_mfma_f32_32x32x16_bf16 v[160:175], a[56:59], v[64:67], v[160:175]
    v_cvt_pk_bf16_f32 v52, v104, v105
    v_cvt_pk_bf16_f32 v53, v106, v107
    v_cvt_pk_bf16_f32 v54, v108, v109
    v_cvt_pk_bf16_f32 v55, v110, v111
    ds_write_b128 v36, v[52:55] offset:48
    s_waitcnt lgkmcnt(5)
    v_mfma_f32_32x32x16_bf16 v[128:143], a[60:63], v[68:71], v[128:143]
    ds_read_b128 v[64:67], v28 offset:256
    v_mfma_f32_32x32x16_bf16 v[144:159], a[64:67], v[68:71], v[144:159]
    s_add_u32 m0, s29, 54272
    s_nop 0
    buffer_load_dwordx4 v13, s[8:11], s26 offen nt lds
    v_mfma_f32_32x32x16_bf16 v[160:175], a[68:71], v[68:71], v[160:175]
    v_cvt_pk_bf16_f32 v56, v112, v113
    v_cvt_pk_bf16_f32 v57, v114, v115
    v_cvt_pk_bf16_f32 v58, v116, v117
    v_cvt_pk_bf16_f32 v59, v118, v119
    ds_write_b128 v36, v[56:59] offset:64
    s_waitcnt lgkmcnt(5)
    v_mfma_f32_32x32x16_bf16 v[128:143], a[72:75], v[72:75], v[128:143]
    ds_read_b128 v[68:71], v29 offset:256
    v_mfma_f32_32x32x16_bf16 v[144:159], a[76:79], v[72:75], v[144:159]
    v_mfma_f32_32x32x16_bf16 v[160:175], a[80:83], v[72:75], v[160:175]
    v_cvt_pk_bf16_f32 v60, v120, v121
    v_cvt_pk_bf16_f32 v61, v122, v123
    v_cvt_pk_bf16_f32 v62, v124, v125
    v_cvt_pk_bf16_f32 v63, v126, v127
    ds_write_b128 v36, v[60:63] offset:80
    s_waitcnt lgkmcnt(5)
    v_mfma_f32_32x32x16_bf16 v[128:143], a[84:87], v[76:79], v[128:143]
    ds_read_b128 v[72:75], v30 offset:256
    v_mfma_f32_32x32x16_bf16 v[144:159], a[88:91], v[76:79], v[144:159]
    v_mfma_f32_32x32x16_bf16 v[160:175], a[92:95], v[76:79], v[160:175]
    ds_read_b128 v[40:43], v37 offset:0
    s_waitcnt lgkmcnt(5)
    v_mfma_f32_32x32x16_bf16 v[128:143], a[96:99], v[64:67], v[128:143]
    ds_read_b128 v[76:79], v31 offset:256
    v_mfma_f32_32x32x16_bf16 v[144:159], a[100:103], v[64:67], v[144:159]
    v_mfma_f32_32x32x16_bf16 v[160:175], a[104:107], v[64:67], v[160:175]
    ds_read_b128 v[44:47], v37 offset:1024
    s_waitcnt lgkmcnt(5)
    v_mfma_f32_32x32x16_bf16 v[128:143], a[108:111], v[68:71], v[128:143]
    ds_read_b128 v[64:67], v32 offset:256
    v_mfma_f32_32x32x16_bf16 v[144:159], a[112:115], v[68:71], v[144:159]
    v_mfma_f32_32x32x16_bf16 v[160:175], a[116:119], v[68:71], v[160:175]
    ds_read_b128 v[48:51], v37 offset:2048
    s_waitcnt lgkmcnt(5)
    v_mfma_f32_32x32x16_bf16 v[128:143], a[120:123], v[72:75], v[128:143]
    ds_read_b128 v[68:71], v33 offset:256
    v_mfma_f32_32x32x16_bf16 v[144:159], a[124:127], v[72:75], v[144:159]
    v_mfma_f32_32x32x16_bf16 v[160:175], a[128:131], v[72:75], v[160:175]
    ds_read_b128 v[52:55], v37 offset:3072
    s_waitcnt lgkmcnt(5)
    v_mfma_f32_32x32x16_bf16 v[128:143], a[132:135], v[76:79], v[128:143]
    ds_read_b128 v[72:75], v34 offset:256
    v_mfma_f32_32x32x16_bf16 v[144:159], a[136:139], v[76:79], v[144:159]
    v_mfma_f32_32x32x16_bf16 v[160:175], a[140:143], v[76:79], v[160:175]
    ds_read_b128 v[56:59], v37 offset:4096
    s_waitcnt lgkmcnt(5)
    v_mfma_f32_32x32x16_bf16 v[128:143], a[144:147], v[64:67], v[128:143]
    ds_read_b128 v[76:79], v35 offset:256
    v_mfma_f32_32x32x16_bf16 v[144:159], a[148:151], v[64:67], v[144:159]
    v_mfma_f32_32x32x16_bf16 v[160:175], a[152:155], v[64:67], v[160:175]
    ds_read_b128 v[60:63], v37 offset:5120
    s_waitcnt lgkmcnt(5)
    v_mfma_f32_32x32x16_bf16 v[128:143], a[156:159], v[68:71], v[128:143]
    ds_read_b128 v[64:67], v28 offset:512
    v_mfma_f32_32x32x16_bf16 v[144:159], a[160:163], v[68:71], v[144:159]
    v_mfma_f32_32x32x16_bf16 v[160:175], a[164:167], v[68:71], v[160:175]
    s_add_u32 s32, s25, 49152
    s_waitcnt lgkmcnt(11)
    buffer_store_dwordx4 v[40:43], v14, s[20:23], s32 offen nt
    s_waitcnt lgkmcnt(4)
    v_mfma_f32_32x32x16_bf16 v[128:143], a[168:171], v[72:75], v[128:143]
    ds_read_b128 v[68:71], v29 offset:512
    v_mfma_f32_32x32x16_bf16 v[144:159], a[172:175], v[72:75], v[144:159]
    v_mfma_f32_32x32x16_bf16 v[160:175], a[176:179], v[72:75], v[160:175]
    s_waitcnt lgkmcnt(10)
    buffer_store_dwordx4 v[44:47], v15, s[20:23], s32 offen nt
    s_waitcnt lgkmcnt(3)
    v_mfma_f32_32x32x16_bf16 v[128:143], a[180:183], v[76:79], v[128:143]
    ds_read_b128 v[72:75], v30 offset:512
    v_mfma_f32_32x32x16_bf16 v[144:159], a[184:187], v[76:79], v[144:159]
    v_mfma_f32_32x32x16_bf16 v[160:175], a[188:191], v[76:79], v[160:175]
    s_waitcnt lgkmcnt(9)
    buffer_store_dwordx4 v[48:51], v16, s[20:23], s32 offen nt
    s_waitcnt lgkmcnt(2)
    v_mfma_f32_32x32x16_bf16 v[128:143], a[192:195], v[64:67], v[128:143]
    ds_read_b128 v[76:79], v31 offset:512
    v_mfma_f32_32x32x16_bf16 v[144:159], a[196:199], v[64:67], v[144:159]
    v_mfma_f32_32x32x16_bf16 v[160:175], a[200:203], v[64:67], v[160:175]
    s_waitcnt lgkmcnt(8)
    buffer_store_dwordx4 v[52:55], v17, s[20:23], s32 offen nt
    s_waitcnt lgkmcnt(2)
    v_mfma_f32_32x32x16_bf16 v[128:143], a[204:207], v[68:71], v[128:143]
    ds_read_b128 v[64:67], v32 offset:512
    v_mfma_f32_32x32x16_bf16 v[144:159], a[208:211], v[68:71], v[144:159]
    v_mfma_f32_32x32x16_bf16 v[160:175], a[212:215], v[68:71], v[160:175]
    s_waitcnt lgkmcnt(7)
    buffer_store_dwordx4 v[56:59], v18, s[20:23], s32 offen nt
    s_waitcnt lgkmcnt(2)
    v_mfma_f32_32x32x16_bf16 v[128:143], a[216:219], v[72:75], v[128:143]
    ds_read_b128 v[68:71], v33 offset:512
    v_mfma_f32_32x32x16_bf16 v[144:159], a[220:223], v[72:75], v[144:159]
    v_mfma_f32_32x32x16_bf16 v[160:175], a[224:227], v[72:75], v[160:175]
    s_waitcnt lgkmcnt(6)
    buffer_store_dwordx4 v[60:63], v19, s[20:23], s32 offen nt
    s_waitcnt lgkmcnt(2)
    v_mfma_f32_32x32x16_bf16 v[128:143], a[228:231], v[76:79], v[128:143]
    ds_read_b128 v[72:75], v34 offset:512
    v_mfma_f32_32x32x16_bf16 v[144:159], a[232:235], v[76:79], v[144:159]
    v_mfma_f32_32x32x16_bf16 v[160:175], a[236:239], v[76:79], v[160:175]
    s_waitcnt lgkmcnt(2)
    v_mfma_f32_32x32x16_bf16 v[128:143], a[240:243], v[64:67], v[128:143]
    ds_read_b128 v[76:79], v35 offset:512
    v_mfma_f32_32x32x16_bf16 v[144:159], a[244:247], v[64:67], v[144:159]
    v_mfma_f32_32x32x16_bf16 v[160:175], a[248:251], v[64:67], v[160:175]
    s_waitcnt lgkmcnt(2)
    v_mfma_f32_32x32x16_bf16 v[128:143], a[252:255], v[68:71], v[128:143]
    v_mfma_f32_32x32x16_bf16 v[144:159], v[224:227], v[68:71], v[144:159]
    v_mfma_f32_32x32x16_bf16 v[160:175], v[228:231], v[68:71], v[160:175]
    s_waitcnt lgkmcnt(1)
    v_mfma_f32_32x32x16_bf16 v[128:143], v[232:235], v[72:75], v[128:143]
    v_mfma_f32_32x32x16_bf16 v[144:159], v[236:239], v[72:75], v[144:159]
    v_mfma_f32_32x32x16_bf16 v[160:175], v[240:243], v[72:75], v[160:175]
    s_waitcnt lgkmcnt(0)
    v_mfma_f32_32x32x16_bf16 v[128:143], v[244:247], v[76:79], v[128:143]
    v_mfma_f32_32x32x16_bf16 v[144:159], v[248:251], v[76:79], v[144:159]
    v_mfma_f32_32x32x16_bf16 v[160:175], v[252:255], v[76:79], v[160:175]
    s_waitcnt vmcnt(36)
    s_barrier
    v_add_u32 v28, 98304, v20
    v_add_u32 v29, 98304, v21
    v_add_u32 v30, 98304, v22
    v_add_u32 v31, 98304, v23
    v_add_u32 v32, 98304, v24
    v_add_u32 v33, 98304, v25
    v_add_u32 v34, 98304, v26
    v_add_u32 v35, 98304, v27
    ds_read_b128 v[64:67], v28 offset:0
    ds_read_b128 v[68:71], v29 offset:0
    ds_read_b128 v[72:75], v30 offset:0
    s_waitcnt lgkmcnt(2)
    v_mfma_f32_32x32x16_bf16 v[80:95], a[0:3], v[64:67], v[176:191]
    ds_read_b128 v[76:79], v31 offset:0
    v_mfma_f32_32x32x16_bf16 v[96:111], a[4:7], v[64:67], v[192:207]
    v_mfma_f32_32x32x16_bf16 v[112:127], a[8:11], v[64:67], v[208:223]
    s_waitcnt lgkmcnt(2)
    v_mfma_f32_32x32x16_bf16 v[80:95], a[12:15], v[68:71], v[80:95]
    ds_read_b128 v[64:67], v32 offset:0
    v_mfma_f32_32x32x16_bf16 v[96:111], a[16:19], v[68:71], v[96:111]
    v_mfma_f32_32x32x16_bf16 v[112:127], a[20:23], v[68:71], v[112:127]
    v_cvt_pk_bf16_f32 v40, v128, v129
    v_cvt_pk_bf16_f32 v41, v130, v131
    v_cvt_pk_bf16_f32 v42, v132, v133
    v_cvt_pk_bf16_f32 v43, v134, v135
    ds_write_b128 v36, v[40:43] offset:0
    s_waitcnt lgkmcnt(3)
    v_mfma_f32_32x32x16_bf16 v[80:95], a[24:27], v[72:75], v[80:95]
    ds_read_b128 v[68:71], v33 offset:0
    v_mfma_f32_32x32x16_bf16 v[96:111], a[28:31], v[72:75], v[96:111]
    v_mfma_f32_32x32x16_bf16 v[112:127], a[32:35], v[72:75], v[112:127]
    v_cvt_pk_bf16_f32 v44, v136, v137
    v_cvt_pk_bf16_f32 v45, v138, v139
    v_cvt_pk_bf16_f32 v46, v140, v141
    v_cvt_pk_bf16_f32 v47, v142, v143
    ds_write_b128 v36, v[44:47] offset:16
    s_waitcnt lgkmcnt(4)
    v_mfma_f32_32x32x16_bf16 v[80:95], a[36:39], v[76:79], v[80:95]
    ds_read_b128 v[72:75], v34 offset:0
    v_mfma_f32_32x32x16_bf16 v[96:111], a[40:43], v[76:79], v[96:111]
    v_mfma_f32_32x32x16_bf16 v[112:127], a[44:47], v[76:79], v[112:127]
    v_cvt_pk_bf16_f32 v48, v144, v145
    v_cvt_pk_bf16_f32 v49, v146, v147
    v_cvt_pk_bf16_f32 v50, v148, v149
    v_cvt_pk_bf16_f32 v51, v150, v151
    ds_write_b128 v36, v[48:51] offset:32
    s_waitcnt lgkmcnt(5)
    v_mfma_f32_32x32x16_bf16 v[80:95], a[48:51], v[64:67], v[80:95]
    ds_read_b128 v[76:79], v35 offset:0
    v_mfma_f32_32x32x16_bf16 v[96:111], a[52:55], v[64:67], v[96:111]
    v_mfma_f32_32x32x16_bf16 v[112:127], a[56:59], v[64:67], v[112:127]
    v_cvt_pk_bf16_f32 v52, v152, v153
    v_cvt_pk_bf16_f32 v53, v154, v155
    v_cvt_pk_bf16_f32 v54, v156, v157
    v_cvt_pk_bf16_f32 v55, v158, v159
    ds_write_b128 v36, v[52:55] offset:48
    s_waitcnt lgkmcnt(5)
    v_mfma_f32_32x32x16_bf16 v[80:95], a[60:63], v[68:71], v[80:95]
    ds_read_b128 v[64:67], v28 offset:256
    v_mfma_f32_32x32x16_bf16 v[96:111], a[64:67], v[68:71], v[96:111]
    v_mfma_f32_32x32x16_bf16 v[112:127], a[68:71], v[68:71], v[112:127]
    v_cvt_pk_bf16_f32 v56, v160, v161
    v_cvt_pk_bf16_f32 v57, v162, v163
    v_cvt_pk_bf16_f32 v58, v164, v165
    v_cvt_pk_bf16_f32 v59, v166, v167
    ds_write_b128 v36, v[56:59] offset:64
    s_waitcnt lgkmcnt(5)
    v_mfma_f32_32x32x16_bf16 v[80:95], a[72:75], v[72:75], v[80:95]
    ds_read_b128 v[68:71], v29 offset:256
    v_mfma_f32_32x32x16_bf16 v[96:111], a[76:79], v[72:75], v[96:111]
    v_mfma_f32_32x32x16_bf16 v[112:127], a[80:83], v[72:75], v[112:127]
    v_cvt_pk_bf16_f32 v60, v168, v169
    v_cvt_pk_bf16_f32 v61, v170, v171
    v_cvt_pk_bf16_f32 v62, v172, v173
    v_cvt_pk_bf16_f32 v63, v174, v175
    ds_write_b128 v36, v[60:63] offset:80
    s_waitcnt lgkmcnt(5)
    v_mfma_f32_32x32x16_bf16 v[80:95], a[84:87], v[76:79], v[80:95]
    ds_read_b128 v[72:75], v30 offset:256
    v_mfma_f32_32x32x16_bf16 v[96:111], a[88:91], v[76:79], v[96:111]
    v_mfma_f32_32x32x16_bf16 v[112:127], a[92:95], v[76:79], v[112:127]
    ds_read_b128 v[40:43], v37 offset:0
    s_waitcnt lgkmcnt(5)
    v_mfma_f32_32x32x16_bf16 v[80:95], a[96:99], v[64:67], v[80:95]
    ds_read_b128 v[76:79], v31 offset:256
    v_mfma_f32_32x32x16_bf16 v[96:111], a[100:103], v[64:67], v[96:111]
    v_mfma_f32_32x32x16_bf16 v[112:127], a[104:107], v[64:67], v[112:127]
    ds_read_b128 v[44:47], v37 offset:1024
    s_waitcnt lgkmcnt(5)
    v_mfma_f32_32x32x16_bf16 v[80:95], a[108:111], v[68:71], v[80:95]
    ds_read_b128 v[64:67], v32 offset:256
    v_mfma_f32_32x32x16_bf16 v[96:111], a[112:115], v[68:71], v[96:111]
    v_mfma_f32_32x32x16_bf16 v[112:127], a[116:119], v[68:71], v[112:127]
    ds_read_b128 v[48:51], v37 offset:2048
    s_waitcnt lgkmcnt(5)
    v_mfma_f32_32x32x16_bf16 v[80:95], a[120:123], v[72:75], v[80:95]
    ds_read_b128 v[68:71], v33 offset:256
    v_mfma_f32_32x32x16_bf16 v[96:111], a[124:127], v[72:75], v[96:111]
    v_mfma_f32_32x32x16_bf16 v[112:127], a[128:131], v[72:75], v[112:127]
    ds_read_b128 v[52:55], v37 offset:3072
    s_waitcnt lgkmcnt(5)
    v_mfma_f32_32x32x16_bf16 v[80:95], a[132:135], v[76:79], v[80:95]
    ds_read_b128 v[72:75], v34 offset:256
    v_mfma_f32_32x32x16_bf16 v[96:111], a[136:139], v[76:79], v[96:111]
    v_mfma_f32_32x32x16_bf16 v[112:127], a[140:143], v[76:79], v[112:127]
    ds_read_b128 v[56:59], v37 offset:4096
    s_waitcnt lgkmcnt(5)
    v_mfma_f32_32x32x16_bf16 v[80:95], a[144:147], v[64:67], v[80:95]
    ds_read_b128 v[76:79], v35 offset:256
    v_mfma_f32_32x32x16_bf16 v[96:111], a[148:151], v[64:67], v[96:111]
    v_mfma_f32_32x32x16_bf16 v[112:127], a[152:155], v[64:67], v[112:127]
    ds_read_b128 v[60:63], v37 offset:5120
    s_waitcnt lgkmcnt(5)
    v_mfma_f32_32x32x16_bf16 v[80:95], a[156:159], v[68:71], v[80:95]
    ds_read_b128 v[64:67], v28 offset:512
    v_mfma_f32_32x32x16_bf16 v[96:111], a[160:163], v[68:71], v[96:111]
    v_mfma_f32_32x32x16_bf16 v[112:127], a[164:167], v[68:71], v[112:127]
    s_add_u32 s32, s25, 73728
    s_waitcnt lgkmcnt(11)
    buffer_store_dwordx4 v[40:43], v14, s[20:23], s32 offen nt
    s_waitcnt lgkmcnt(4)
    v_mfma_f32_32x32x16_bf16 v[80:95], a[168:171], v[72:75], v[80:95]
    ds_read_b128 v[68:71], v29 offset:512
    v_mfma_f32_32x32x16_bf16 v[96:111], a[172:175], v[72:75], v[96:111]
    v_mfma_f32_32x32x16_bf16 v[112:127], a[176:179], v[72:75], v[112:127]
    s_waitcnt lgkmcnt(10)
    buffer_store_dwordx4 v[44:47], v15, s[20:23], s32 offen nt
    s_waitcnt lgkmcnt(3)
    v_mfma_f32_32x32x16_bf16 v[80:95], a[180:183], v[76:79], v[80:95]
    ds_read_b128 v[72:75], v30 offset:512
    v_mfma_f32_32x32x16_bf16 v[96:111], a[184:187], v[76:79], v[96:111]
    v_mfma_f32_32x32x16_bf16 v[112:127], a[188:191], v[76:79], v[112:127]
    s_waitcnt lgkmcnt(9)
    buffer_store_dwordx4 v[48:51], v16, s[20:23], s32 offen nt
    s_waitcnt lgkmcnt(2)
    v_mfma_f32_32x32x16_bf16 v[80:95], a[192:195], v[64:67], v[80:95]
    ds_read_b128 v[76:79], v31 offset:512
    v_mfma_f32_32x32x16_bf16 v[96:111], a[196:199], v[64:67], v[96:111]
    v_mfma_f32_32x32x16_bf16 v[112:127], a[200:203], v[64:67], v[112:127]
    s_waitcnt lgkmcnt(8)
    buffer_store_dwordx4 v[52:55], v17, s[20:23], s32 offen nt
    s_waitcnt lgkmcnt(2)
    v_mfma_f32_32x32x16_bf16 v[80:95], a[204:207], v[68:71], v[80:95]
    ds_read_b128 v[64:67], v32 offset:512
    v_mfma_f32_32x32x16_bf16 v[96:111], a[208:211], v[68:71], v[96:111]
    v_mfma_f32_32x32x16_bf16 v[112:127], a[212:215], v[68:71], v[112:127]
    s_waitcnt lgkmcnt(7)
    buffer_store_dwordx4 v[56:59], v18, s[20:23], s32 offen nt
    s_waitcnt lgkmcnt(2)
    v_mfma_f32_32x32x16_bf16 v[80:95], a[216:219], v[72:75], v[80:95]
    ds_read_b128 v[68:71], v33 offset:512
    v_mfma_f32_32x32x16_bf16 v[96:111], a[220:223], v[72:75], v[96:111]
    v_mfma_f32_32x32x16_bf16 v[112:127], a[224:227], v[72:75], v[112:127]
    s_waitcnt lgkmcnt(6)
    buffer_store_dwordx4 v[60:63], v19, s[20:23], s32 offen nt
    s_waitcnt lgkmcnt(2)
    v_mfma_f32_32x32x16_bf16 v[80:95], a[228:231], v[76:79], v[80:95]
    ds_read_b128 v[72:75], v34 offset:512
    v_mfma_f32_32x32x16_bf16 v[96:111], a[232:235], v[76:79], v[96:111]
    v_mfma_f32_32x32x16_bf16 v[112:127], a[236:239], v[76:79], v[112:127]
    s_waitcnt lgkmcnt(2)
    v_mfma_f32_32x32x16_bf16 v[80:95], a[240:243], v[64:67], v[80:95]
    ds_read_b128 v[76:79], v35 offset:512
    v_mfma_f32_32x32x16_bf16 v[96:111], a[244:247], v[64:67], v[96:111]
    v_mfma_f32_32x32x16_bf16 v[112:127], a[248:251], v[64:67], v[112:127]
    s_waitcnt lgkmcnt(2)
    v_mfma_f32_32x32x16_bf16 v[80:95], a[252:255], v[68:71], v[80:95]
    v_mfma_f32_32x32x16_bf16 v[96:111], v[224:227], v[68:71], v[96:111]
    v_mfma_f32_32x32x16_bf16 v[112:127], v[228:231], v[68:71], v[112:127]
    s_waitcnt lgkmcnt(1)
    v_mfma_f32_32x32x16_bf16 v[80:95], v[232:235], v[72:75], v[80:95]
    v_mfma_f32_32x32x16_bf16 v[96:111], v[236:239], v[72:75], v[96:111]
    v_mfma_f32_32x32x16_bf16 v[112:127], v[240:243], v[72:75], v[112:127]
    s_waitcnt lgkmcnt(0)
    v_mfma_f32_32x32x16_bf16 v[80:95], v[244:247], v[76:79], v[80:95]
    v_mfma_f32_32x32x16_bf16 v[96:111], v[248:251], v[76:79], v[96:111]
    v_mfma_f32_32x32x16_bf16 v[112:127], v[252:255], v[76:79], v[112:127]
    s_waitcnt vmcnt(36)
    s_barrier
    v_add_u32 v28, 0, v20
    v_add_u32 v29, 0, v21
    v_add_u32 v30, 0, v22
    v_add_u32 v31, 0, v23
    v_add_u32 v32, 0, v24
    v_add_u32 v33, 0, v25
    v_add_u32 v34, 0, v26
    v_add_u32 v35, 0, v27
    ds_read_b128 v[64:67], v28 offset:0
    ds_read_b128 v[68:71], v29 offset:0
    ds_read_b128 v[72:75], v30 offset:0
    s_waitcnt lgkmcnt(2)
    v_mfma_f32_32x32x16_bf16 v[128:143], a[0:3], v[64:67], v[176:191]
    ds_read_b128 v[76:79], v31 offset:0
    v_mfma_f32_32x32x16_bf16 v[144:159], a[4:7], v[64:67], v[192:207]
    v_mfma_f32_32x32x16_bf16 v[160:175], a[8:11], v[64:67], v[208:223]
    s_waitcnt lgkmcnt(2)
    v_mfma_f32_32x32x16_bf16 v[128:143], a[12:15], v[68:71], v[128:143]
    ds_read_b128 v[64:67], v32 offset:0
    v_mfma_f32_32x32x16_bf16 v[144:159], a[16:19], v[68:71], v[144:159]
    v_mfma_f32_32x32x16_bf16 v[160:175], a[20:23], v[68:71], v[160:175]
    v_cvt_pk_bf16_f32 v40, v80, v81
    v_cvt_pk_bf16_f32 v41, v82, v83
    v_cvt_pk_bf16_f32 v42, v84, v85
    v_cvt_pk_bf16_f32 v43, v86, v87
    ds_write_b128 v36, v[40:43] offset:0
    s_waitcnt lgkmcnt(3)
    v_mfma_f32_32x32x16_bf16 v[128:143], a[24:27], v[72:75], v[128:143]
    ds_read_b128 v[68:71], v33 offset:0
    v_mfma_f32_32x32x16_bf16 v[144:159], a[28:31], v[72:75], v[144:159]
    v_mfma_f32_32x32x16_bf16 v[160:175], a[32:35], v[72:75], v[160:175]
    v_cvt_pk_bf16_f32 v44, v88, v89
    v_cvt_pk_bf16_f32 v45, v90, v91
    v_cvt_pk_bf16_f32 v46, v92, v93
    v_cvt_pk_bf16_f32 v47, v94, v95
    ds_write_b128 v36, v[44:47] offset:16
    s_waitcnt lgkmcnt(4)
    v_mfma_f32_32x32x16_bf16 v[128:143], a[36:39], v[76:79], v[128:143]
    ds_read_b128 v[72:75], v34 offset:0
    v_mfma_f32_32x32x16_bf16 v[144:159], a[40:43], v[76:79], v[144:159]
    v_mfma_f32_32x32x16_bf16 v[160:175], a[44:47], v[76:79], v[160:175]
    v_cvt_pk_bf16_f32 v48, v96, v97
    v_cvt_pk_bf16_f32 v49, v98, v99
    v_cvt_pk_bf16_f32 v50, v100, v101
    v_cvt_pk_bf16_f32 v51, v102, v103
    ds_write_b128 v36, v[48:51] offset:32
    s_waitcnt lgkmcnt(5)
    v_mfma_f32_32x32x16_bf16 v[128:143], a[48:51], v[64:67], v[128:143]
    ds_read_b128 v[76:79], v35 offset:0
    v_mfma_f32_32x32x16_bf16 v[144:159], a[52:55], v[64:67], v[144:159]
    v_mfma_f32_32x32x16_bf16 v[160:175], a[56:59], v[64:67], v[160:175]
    v_cvt_pk_bf16_f32 v52, v104, v105
    v_cvt_pk_bf16_f32 v53, v106, v107
    v_cvt_pk_bf16_f32 v54, v108, v109
    v_cvt_pk_bf16_f32 v55, v110, v111
    ds_write_b128 v36, v[52:55] offset:48
    s_waitcnt lgkmcnt(5)
    v_mfma_f32_32x32x16_bf16 v[128:143], a[60:63], v[68:71], v[128:143]
    ds_read_b128 v[64:67], v28 offset:256
    v_mfma_f32_32x32x16_bf16 v[144:159], a[64:67], v[68:71], v[144:159]
    v_mfma_f32_32x32x16_bf16 v[160:175], a[68:71], v[68:71], v[160:175]
    v_cvt_pk_bf16_f32 v56, v112, v113
    v_cvt_pk_bf16_f32 v57, v114, v115
    v_cvt_pk_bf16_f32 v58, v116, v117
    v_cvt_pk_bf16_f32 v59, v118, v119
    ds_write_b128 v36, v[56:59] offset:64
    s_waitcnt lgkmcnt(5)
    v_mfma_f32_32x32x16_bf16 v[128:143], a[72:75], v[72:75], v[128:143]
    ds_read_b128 v[68:71], v29 offset:256
    v_mfma_f32_32x32x16_bf16 v[144:159], a[76:79], v[72:75], v[144:159]
    v_mfma_f32_32x32x16_bf16 v[160:175], a[80:83], v[72:75], v[160:175]
    v_cvt_pk_bf16_f32 v60, v120, v121
    v_cvt_pk_bf16_f32 v61, v122, v123
    v_cvt_pk_bf16_f32 v62, v124, v125
    v_cvt_pk_bf16_f32 v63, v126, v127
    ds_write_b128 v36, v[60:63] offset:80
    s_waitcnt lgkmcnt(5)
    v_mfma_f32_32x32x16_bf16 v[128:143], a[84:87], v[76:79], v[128:143]
    ds_read_b128 v[72:75], v30 offset:256
    v_mfma_f32_32x32x16_bf16 v[144:159], a[88:91], v[76:79], v[144:159]
    v_mfma_f32_32x32x16_bf16 v[160:175], a[92:95], v[76:79], v[160:175]
    ds_read_b128 v[40:43], v37 offset:0
    s_waitcnt lgkmcnt(5)
    v_mfma_f32_32x32x16_bf16 v[128:143], a[96:99], v[64:67], v[128:143]
    ds_read_b128 v[76:79], v31 offset:256
    v_mfma_f32_32x32x16_bf16 v[144:159], a[100:103], v[64:67], v[144:159]
    v_mfma_f32_32x32x16_bf16 v[160:175], a[104:107], v[64:67], v[160:175]
    ds_read_b128 v[44:47], v37 offset:1024
    s_waitcnt lgkmcnt(5)
    v_mfma_f32_32x32x16_bf16 v[128:143], a[108:111], v[68:71], v[128:143]
    ds_read_b128 v[64:67], v32 offset:256
    v_mfma_f32_32x32x16_bf16 v[144:159], a[112:115], v[68:71], v[144:159]
    v_mfma_f32_32x32x16_bf16 v[160:175], a[116:119], v[68:71], v[160:175]
    ds_read_b128 v[48:51], v37 offset:2048
    s_waitcnt lgkmcnt(5)
    v_mfma_f32_32x32x16_bf16 v[128:143], a[120:123], v[72:75], v[128:143]
    ds_read_b128 v[68:71], v33 offset:256
    v_mfma_f32_32x32x16_bf16 v[144:159], a[124:127], v[72:75], v[144:159]
    v_mfma_f32_32x32x16_bf16 v[160:175], a[128:131], v[72:75], v[160:175]
    ds_read_b128 v[52:55], v37 offset:3072
    s_waitcnt lgkmcnt(5)
    v_mfma_f32_32x32x16_bf16 v[128:143], a[132:135], v[76:79], v[128:143]
    ds_read_b128 v[72:75], v34 offset:256
    v_mfma_f32_32x32x16_bf16 v[144:159], a[136:139], v[76:79], v[144:159]
    v_mfma_f32_32x32x16_bf16 v[160:175], a[140:143], v[76:79], v[160:175]
    ds_read_b128 v[56:59], v37 offset:4096
    s_waitcnt lgkmcnt(5)
    v_mfma_f32_32x32x16_bf16 v[128:143], a[144:147], v[64:67], v[128:143]
    ds_read_b128 v[76:79], v35 offset:256
    v_mfma_f32_32x32x16_bf16 v[144:159], a[148:151], v[64:67], v[144:159]
    v_mfma_f32_32x32x16_bf16 v[160:175], a[152:155], v[64:67], v[160:175]
    ds_read_b128 v[60:63], v37 offset:5120
    s_waitcnt lgkmcnt(5)
    v_mfma_f32_32x32x16_bf16 v[128:143], a[156:159], v[68:71], v[128:143]
    ds_read_b128 v[64:67], v28 offset:512
    v_mfma_f32_32x32x16_bf16 v[144:159], a[160:163], v[68:71], v[144:159]
    v_mfma_f32_32x32x16_bf16 v[160:175], a[164:167], v[68:71], v[160:175]
    s_add_u32 s32, s25, 98304
    s_waitcnt lgkmcnt(11)
    buffer_store_dwordx4 v[40:43], v14, s[20:23], s32 offen nt
    s_waitcnt lgkmcnt(4)
    v_mfma_f32_32x32x16_bf16 v[128:143], a[168:171], v[72:75], v[128:143]
    ds_read_b128 v[68:71], v29 offset:512
    v_mfma_f32_32x32x16_bf16 v[144:159], a[172:175], v[72:75], v[144:159]
    v_mfma_f32_32x32x16_bf16 v[160:175], a[176:179], v[72:75], v[160:175]
    s_waitcnt lgkmcnt(10)
    buffer_store_dwordx4 v[44:47], v15, s[20:23], s32 offen nt
    s_waitcnt lgkmcnt(3)
    v_mfma_f32_32x32x16_bf16 v[128:143], a[180:183], v[76:79], v[128:143]
    ds_read_b128 v[72:75], v30 offset:512
    v_mfma_f32_32x32x16_bf16 v[144:159], a[184:187], v[76:79], v[144:159]
    v_mfma_f32_32x32x16_bf16 v[160:175], a[188:191], v[76:79], v[160:175]
    s_waitcnt lgkmcnt(9)
    buffer_store_dwordx4 v[48:51], v16, s[20:23], s32 offen nt
    s_waitcnt lgkmcnt(2)
    v_mfma_f32_32x32x16_bf16 v[128:143], a[192:195], v[64:67], v[128:143]
    ds_read_b128 v[76:79], v31 offset:512
    v_mfma_f32_32x32x16_bf16 v[144:159], a[196:199], v[64:67], v[144:159]
    v_mfma_f32_32x32x16_bf16 v[160:175], a[200:203], v[64:67], v[160:175]
    s_waitcnt lgkmcnt(8)
    buffer_store_dwordx4 v[52:55], v17, s[20:23], s32 offen nt
    s_waitcnt lgkmcnt(2)
    v_mfma_f32_32x32x16_bf16 v[128:143], a[204:207], v[68:71], v[128:143]
    ds_read_b128 v[64:67], v32 offset:512
    v_mfma_f32_32x32x16_bf16 v[144:159], a[208:211], v[68:71], v[144:159]
    v_mfma_f32_32x32x16_bf16 v[160:175], a[212:215], v[68:71], v[160:175]
    s_waitcnt lgkmcnt(7)
    buffer_store_dwordx4 v[56:59], v18, s[20:23], s32 offen nt
    s_waitcnt lgkmcnt(2)
    v_mfma_f32_32x32x16_bf16 v[128:143], a[216:219], v[72:75], v[128:143]
    ds_read_b128 v[68:71], v33 offset:512
    v_mfma_f32_32x32x16_bf16 v[144:159], a[220:223], v[72:75], v[144:159]
    v_mfma_f32_32x32x16_bf16 v[160:175], a[224:227], v[72:75], v[160:175]
    s_waitcnt lgkmcnt(6)
    buffer_store_dwordx4 v[60:63], v19, s[20:23], s32 offen nt
    s_waitcnt lgkmcnt(2)
    v_mfma_f32_32x32x16_bf16 v[128:143], a[228:231], v[76:79], v[128:143]
    ds_read_b128 v[72:75], v34 offset:512
    v_mfma_f32_32x32x16_bf16 v[144:159], a[232:235], v[76:79], v[144:159]
    v_mfma_f32_32x32x16_bf16 v[160:175], a[236:239], v[76:79], v[160:175]
    s_waitcnt lgkmcnt(2)
    v_mfma_f32_32x32x16_bf16 v[128:143], a[240:243], v[64:67], v[128:143]
    ds_read_b128 v[76:79], v35 offset:512
    v_mfma_f32_32x32x16_bf16 v[144:159], a[244:247], v[64:67], v[144:159]
    v_mfma_f32_32x32x16_bf16 v[160:175], a[248:251], v[64:67], v[160:175]
    s_waitcnt lgkmcnt(2)
    v_mfma_f32_32x32x16_bf16 v[128:143], a[252:255], v[68:71], v[128:143]
    v_mfma_f32_32x32x16_bf16 v[144:159], v[224:227], v[68:71], v[144:159]
    v_mfma_f32_32x32x16_bf16 v[160:175], v[228:231], v[68:71], v[160:175]
    s_waitcnt lgkmcnt(1)
    v_mfma_f32_32x32x16_bf16 v[128:143], v[232:235], v[72:75], v[128:143]
    v_mfma_f32_32x32x16_bf16 v[144:159], v[236:239], v[72:75], v[144:159]
    v_mfma_f32_32x32x16_bf16 v[160:175], v[240:243], v[72:75], v[160:175]
    s_waitcnt lgkmcnt(0)
    v_mfma_f32_32x32x16_bf16 v[128:143], v[244:247], v[76:79], v[128:143]
    v_mfma_f32_32x32x16_bf16 v[144:159], v[248:251], v[76:79], v[144:159]
    v_mfma_f32_32x32x16_bf16 v[160:175], v[252:255], v[76:79], v[160:175]
    s_waitcnt vmcnt(36)
    s_barrier
    v_add_u32 v28, 24576, v20
    v_add_u32 v29, 24576, v21
    v_add_u32 v30, 24576, v22
    v_add_u32 v31, 24576, v23
    v_add_u32 v32, 24576, v24
    v_add_u32 v33, 24576, v25
    v_add_u32 v34, 24576, v26
    v_add_u32 v35, 24576, v27
    ds_read_b128 v[64:67], v28 offset:0
    ds_read_b128 v[68:71], v29 offset:0
    ds_read_b128 v[72:75], v30 offset:0
    s_waitcnt lgkmcnt(2)
    v_mfma_f32_32x32x16_bf16 v[80:95], a[0:3], v[64:67], v[176:191]
    ds_read_b128 v[76:79], v31 offset:0
    v_mfma_f32_32x32x16_bf16 v[96:111], a[4:7], v[64:67], v[192:207]
    v_mfma_f32_32x32x16_bf16 v[112:127], a[8:11], v[64:67], v[208:223]
    s_waitcnt lgkmcnt(2)
    v_mfma_f32_32x32x16_bf16 v[80:95], a[12:15], v[68:71], v[80:95]
    ds_read_b128 v[64:67], v32 offset:0
    v_mfma_f32_32x32x16_bf16 v[96:111], a[16:19], v[68:71], v[96:111]
    v_mfma_f32_32x32x16_bf16 v[112:127], a[20:23], v[68:71], v[112:127]
    v_cvt_pk_bf16_f32 v40, v128, v129
    v_cvt_pk_bf16_f32 v41, v130, v131
    v_cvt_pk_bf16_f32 v42, v132, v133
    v_cvt_pk_bf16_f32 v43, v134, v135
    ds_write_b128 v36, v[40:43] offset:0
    s_waitcnt lgkmcnt(3)
    v_mfma_f32_32x32x16_bf16 v[80:95], a[24:27], v[72:75], v[80:95]
    ds_read_b128 v[68:71], v33 offset:0
    v_mfma_f32_32x32x16_bf16 v[96:111], a[28:31], v[72:75], v[96:111]
    v_mfma_f32_32x32x16_bf16 v[112:127], a[32:35], v[72:75], v[112:127]
    v_cvt_pk_bf16_f32 v44, v136, v137
    v_cvt_pk_bf16_f32 v45, v138, v139
    v_cvt_pk_bf16_f32 v46, v140, v141
    v_cvt_pk_bf16_f32 v47, v142, v143
    ds_write_b128 v36, v[44:47] offset:16
    s_waitcnt lgkmcnt(4)
    v_mfma_f32_32x32x16_bf16 v[80:95], a[36:39], v[76:79], v[80:95]
    ds_read_b128 v[72:75], v34 offset:0
    v_mfma_f32_32x32x16_bf16 v[96:111], a[40:43], v[76:79], v[96:111]
    v_mfma_f32_32x32x16_bf16 v[112:127], a[44:47], v[76:79], v[112:127]
    v_cvt_pk_bf16_f32 v48, v144, v145
    v_cvt_pk_bf16_f32 v49, v146, v147
    v_cvt_pk_bf16_f32 v50, v148, v149
    v_cvt_pk_bf16_f32 v51, v150, v151
    ds_write_b128 v36, v[48:51] offset:32
    s_waitcnt lgkmcnt(5)
    v_mfma_f32_32x32x16_bf16 v[80:95], a[48:51], v[64:67], v[80:95]
    ds_read_b128 v[76:79], v35 offset:0
    v_mfma_f32_32x32x16_bf16 v[96:111], a[52:55], v[64:67], v[96:111]
    v_mfma_f32_32x32x16_bf16 v[112:127], a[56:59], v[64:67], v[112:127]
    v_cvt_pk_bf16_f32 v52, v152, v153
    v_cvt_pk_bf16_f32 v53, v154, v155
    v_cvt_pk_bf16_f32 v54, v156, v157
    v_cvt_pk_bf16_f32 v55, v158, v159
    ds_write_b128 v36, v[52:55] offset:48
    s_waitcnt lgkmcnt(5)
    v_mfma_f32_32x32x16_bf16 v[80:95], a[60:63], v[68:71], v[80:95]
    ds_read_b128 v[64:67], v28 offset:256
    v_mfma_f32_32x32x16_bf16 v[96:111], a[64:67], v[68:71], v[96:111]
    v_mfma_f32_32x32x16_bf16 v[112:127], a[68:71], v[68:71], v[112:127]
    v_cvt_pk_bf16_f32 v56, v160, v161
    v_cvt_pk_bf16_f32 v57, v162, v163
    v_cvt_pk_bf16_f32 v58, v164, v165
    v_cvt_pk_bf16_f32 v59, v166, v167
    ds_write_b128 v36, v[56:59] offset:64
    s_waitcnt lgkmcnt(5)
    v_mfma_f32_32x32x16_bf16 v[80:95], a[72:75], v[72:75], v[80:95]
    ds_read_b128 v[68:71], v29 offset:256
    v_mfma_f32_32x32x16_bf16 v[96:111], a[76:79], v[72:75], v[96:111]
    v_mfma_f32_32x32x16_bf16 v[112:127], a[80:83], v[72:75], v[112:127]
    v_cvt_pk_bf16_f32 v60, v168, v169
    v_cvt_pk_bf16_f32 v61, v170, v171
    v_cvt_pk_bf16_f32 v62, v172, v173
    v_cvt_pk_bf16_f32 v63, v174, v175
    ds_write_b128 v36, v[60:63] offset:80
    s_waitcnt lgkmcnt(5)
    v_mfma_f32_32x32x16_bf16 v[80:95], a[84:87], v[76:79], v[80:95]
    ds_read_b128 v[72:75], v30 offset:256
    v_mfma_f32_32x32x16_bf16 v[96:111], a[88:91], v[76:79], v[96:111]
    v_mfma_f32_32x32x16_bf16 v[112:127], a[92:95], v[76:79], v[112:127]
    ds_read_b128 v[40:43], v37 offset:0
    s_waitcnt lgkmcnt(5)
    v_mfma_f32_32x32x16_bf16 v[80:95], a[96:99], v[64:67], v[80:95]
    ds_read_b128 v[76:79], v31 offset:256
    v_mfma_f32_32x32x16_bf16 v[96:111], a[100:103], v[64:67], v[96:111]
    v_mfma_f32_32x32x16_bf16 v[112:127], a[104:107], v[64:67], v[112:127]
    ds_read_b128 v[44:47], v37 offset:1024
    s_waitcnt lgkmcnt(5)
    v_mfma_f32_32x32x16_bf16 v[80:95], a[108:111], v[68:71], v[80:95]
    ds_read_b128 v[64:67], v32 offset:256
    v_mfma_f32_32x32x16_bf16 v[96:111], a[112:115], v[68:71], v[96:111]
    v_mfma_f32_32x32x16_bf16 v[112:127], a[116:119], v[68:71], v[112:127]
    ds_read_b128 v[48:51], v37 offset:2048
    s_waitcnt lgkmcnt(5)
    v_mfma_f32_32x32x16_bf16 v[80:95], a[120:123], v[72:75], v[80:95]
    ds_read_b128 v[68:71], v33 offset:256
    v_mfma_f32_32x32x16_bf16 v[96:111], a[124:127], v[72:75], v[96:111]
    v_mfma_f32_32x32x16_bf16 v[112:127], a[128:131], v[72:75], v[112:127]
    ds_read_b128 v[52:55], v37 offset:3072
    s_waitcnt lgkmcnt(5)
    v_mfma_f32_32x32x16_bf16 v[80:95], a[132:135], v[76:79], v[80:95]
    ds_read_b128 v[72:75], v34 offset:256
    v_mfma_f32_32x32x16_bf16 v[96:111], a[136:139], v[76:79], v[96:111]
    v_mfma_f32_32x32x16_bf16 v[112:127], a[140:143], v[76:79], v[112:127]
    ds_read_b128 v[56:59], v37 offset:4096
    s_waitcnt lgkmcnt(5)
    v_mfma_f32_32x32x16_bf16 v[80:95], a[144:147], v[64:67], v[80:95]
    ds_read_b128 v[76:79], v35 offset:256
    v_mfma_f32_32x32x16_bf16 v[96:111], a[148:151], v[64:67], v[96:111]
    v_mfma_f32_32x32x16_bf16 v[112:127], a[152:155], v[64:67], v[112:127]
    ds_read_b128 v[60:63], v37 offset:5120
    s_waitcnt lgkmcnt(5)
    v_mfma_f32_32x32x16_bf16 v[80:95], a[156:159], v[68:71], v[80:95]
    ds_read_b128 v[64:67], v28 offset:512
    v_mfma_f32_32x32x16_bf16 v[96:111], a[160:163], v[68:71], v[96:111]
    v_mfma_f32_32x32x16_bf16 v[112:127], a[164:167], v[68:71], v[112:127]
    s_add_u32 s32, s25, 122880
    s_waitcnt lgkmcnt(11)
    buffer_store_dwordx4 v[40:43], v14, s[20:23], s32 offen nt
    s_waitcnt lgkmcnt(4)
    v_mfma_f32_32x32x16_bf16 v[80:95], a[168:171], v[72:75], v[80:95]
    ds_read_b128 v[68:71], v29 offset:512
    v_mfma_f32_32x32x16_bf16 v[96:111], a[172:175], v[72:75], v[96:111]
    v_mfma_f32_32x32x16_bf16 v[112:127], a[176:179], v[72:75], v[112:127]
    s_waitcnt lgkmcnt(10)
    buffer_store_dwordx4 v[44:47], v15, s[20:23], s32 offen nt
    s_waitcnt lgkmcnt(3)
    v_mfma_f32_32x32x16_bf16 v[80:95], a[180:183], v[76:79], v[80:95]
    ds_read_b128 v[72:75], v30 offset:512
    v_mfma_f32_32x32x16_bf16 v[96:111], a[184:187], v[76:79], v[96:111]
    v_mfma_f32_32x32x16_bf16 v[112:127], a[188:191], v[76:79], v[112:127]
    s_waitcnt lgkmcnt(9)
    buffer_store_dwordx4 v[48:51], v16, s[20:23], s32 offen nt
    s_waitcnt lgkmcnt(2)
    v_mfma_f32_32x32x16_bf16 v[80:95], a[192:195], v[64:67], v[80:95]
    ds_read_b128 v[76:79], v31 offset:512
    v_mfma_f32_32x32x16_bf16 v[96:111], a[196:199], v[64:67], v[96:111]
    v_mfma_f32_32x32x16_bf16 v[112:127], a[200:203], v[64:67], v[112:127]
    s_waitcnt lgkmcnt(8)
    buffer_store_dwordx4 v[52:55], v17, s[20:23], s32 offen nt
    s_waitcnt lgkmcnt(2)
    v_mfma_f32_32x32x16_bf16 v[80:95], a[204:207], v[68:71], v[80:95]
    ds_read_b128 v[64:67], v32 offset:512
    v_mfma_f32_32x32x16_bf16 v[96:111], a[208:211], v[68:71], v[96:111]
    v_mfma_f32_32x32x16_bf16 v[112:127], a[212:215], v[68:71], v[112:127]
    s_waitcnt lgkmcnt(7)
    buffer_store_dwordx4 v[56:59], v18, s[20:23], s32 offen nt
    s_waitcnt lgkmcnt(2)
    v_mfma_f32_32x32x16_bf16 v[80:95], a[216:219], v[72:75], v[80:95]
    ds_read_b128 v[68:71], v33 offset:512
    v_mfma_f32_32x32x16_bf16 v[96:111], a[220:223], v[72:75], v[96:111]
    v_mfma_f32_32x32x16_bf16 v[112:127], a[224:227], v[72:75], v[112:127]
    s_waitcnt lgkmcnt(6)
    buffer_store_dwordx4 v[60:63], v19, s[20:23], s32 offen nt
    s_waitcnt lgkmcnt(2)
    v_mfma_f32_32x32x16_bf16 v[80:95], a[228:231], v[76:79], v[80:95]
    ds_read_b128 v[72:75], v34 offset:512
    v_mfma_f32_32x32x16_bf16 v[96:111], a[232:235], v[76:79], v[96:111]
    v_mfma_f32_32x32x16_bf16 v[112:127], a[236:239], v[76:79], v[112:127]
    s_waitcnt lgkmcnt(2)
    v_mfma_f32_32x32x16_bf16 v[80:95], a[240:243], v[64:67], v[80:95]
    ds_read_b128 v[76:79], v35 offset:512
    v_mfma_f32_32x32x16_bf16 v[96:111], a[244:247], v[64:67], v[96:111]
    v_mfma_f32_32x32x16_bf16 v[112:127], a[248:251], v[64:67], v[112:127]
    s_waitcnt lgkmcnt(2)
    v_mfma_f32_32x32x16_bf16 v[80:95], a[252:255], v[68:71], v[80:95]
    v_mfma_f32_32x32x16_bf16 v[96:111], v[224:227], v[68:71], v[96:111]
    v_mfma_f32_32x32x16_bf16 v[112:127], v[228:231], v[68:71], v[112:127]
    s_waitcnt lgkmcnt(1)
    v_mfma_f32_32x32x16_bf16 v[80:95], v[232:235], v[72:75], v[80:95]
    v_mfma_f32_32x32x16_bf16 v[96:111], v[236:239], v[72:75], v[96:111]
    v_mfma_f32_32x32x16_bf16 v[112:127], v[240:243], v[72:75], v[112:127]
    s_waitcnt lgkmcnt(0)
    v_mfma_f32_32x32x16_bf16 v[80:95], v[244:247], v[76:79], v[80:95]
    v_mfma_f32_32x32x16_bf16 v[96:111], v[248:251], v[76:79], v[96:111]
    v_mfma_f32_32x32x16_bf16 v[112:127], v[252:255], v[76:79], v[112:127]
    s_waitcnt vmcnt(24)
    s_barrier
    v_add_u32 v28, 49152, v20
    v_add_u32 v29, 49152, v21
    v_add_u32 v30, 49152, v22
    v_add_u32 v31, 49152, v23
    v_add_u32 v32, 49152, v24
    v_add_u32 v33, 49152, v25
    v_add_u32 v34, 49152, v26
    v_add_u32 v35, 49152, v27
    ds_read_b128 v[64:67], v28 offset:0
    ds_read_b128 v[68:71], v29 offset:0
    ds_read_b128 v[72:75], v30 offset:0
    s_waitcnt lgkmcnt(2)
    v_mfma_f32_32x32x16_bf16 v[128:143], a[0:3], v[64:67], v[176:191]
    ds_read_b128 v[76:79], v31 offset:0
    v_mfma_f32_32x32x16_bf16 v[144:159], a[4:7], v[64:67], v[192:207]
    v_mfma_f32_32x32x16_bf16 v[160:175], a[8:11], v[64:67], v[208:223]
    s_waitcnt lgkmcnt(2)
    v_mfma_f32_32x32x16_bf16 v[128:143], a[12:15], v[68:71], v[128:143]
    ds_read_b128 v[64:67], v32 offset:0
    v_mfma_f32_32x32x16_bf16 v[144:159], a[16:19], v[68:71], v[144:159]
    v_mfma_f32_32x32x16_bf16 v[160:175], a[20:23], v[68:71], v[160:175]
    v_cvt_pk_bf16_f32 v40, v80, v81
    v_cvt_pk_bf16_f32 v41, v82, v83
    v_cvt_pk_bf16_f32 v42, v84, v85
    v_cvt_pk_bf16_f32 v43, v86, v87
    ds_write_b128 v36, v[40:43] offset:0
    s_waitcnt lgkmcnt(3)
    v_mfma_f32_32x32x16_bf16 v[128:143], a[24:27], v[72:75], v[128:143]
    ds_read_b128 v[68:71], v33 offset:0
    v_mfma_f32_32x32x16_bf16 v[144:159], a[28:31], v[72:75], v[144:159]
    v_mfma_f32_32x32x16_bf16 v[160:175], a[32:35], v[72:75], v[160:175]
    v_cvt_pk_bf16_f32 v44, v88, v89
    v_cvt_pk_bf16_f32 v45, v90, v91
    v_cvt_pk_bf16_f32 v46, v92, v93
    v_cvt_pk_bf16_f32 v47, v94, v95
    ds_write_b128 v36, v[44:47] offset:16
    s_waitcnt lgkmcnt(4)
    v_mfma_f32_32x32x16_bf16 v[128:143], a[36:39], v[76:79], v[128:143]
    ds_read_b128 v[72:75], v34 offset:0
    v_mfma_f32_32x32x16_bf16 v[144:159], a[40:43], v[76:79], v[144:159]
    v_mfma_f32_32x32x16_bf16 v[160:175], a[44:47], v[76:79], v[160:175]
    v_cvt_pk_bf16_f32 v48, v96, v97
    v_cvt_pk_bf16_f32 v49, v98, v99
    v_cvt_pk_bf16_f32 v50, v100, v101
    v_cvt_pk_bf16_f32 v51, v102, v103
    ds_write_b128 v36, v[48:51] offset:32
    s_waitcnt lgkmcnt(5)
    v_mfma_f32_32x32x16_bf16 v[128:143], a[48:51], v[64:67], v[128:143]
    ds_read_b128 v[76:79], v35 offset:0
    v_mfma_f32_32x32x16_bf16 v[144:159], a[52:55], v[64:67], v[144:159]
    v_mfma_f32_32x32x16_bf16 v[160:175], a[56:59], v[64:67], v[160:175]
    v_cvt_pk_bf16_f32 v52, v104, v105
    v_cvt_pk_bf16_f32 v53, v106, v107
    v_cvt_pk_bf16_f32 v54, v108, v109
    v_cvt_pk_bf16_f32 v55, v110, v111
    ds_write_b128 v36, v[52:55] offset:48
    s_waitcnt lgkmcnt(5)
    v_mfma_f32_32x32x16_bf16 v[128:143], a[60:63], v[68:71], v[128:143]
    ds_read_b128 v[64:67], v28 offset:256
    v_mfma_f32_32x32x16_bf16 v[144:159], a[64:67], v[68:71], v[144:159]
    v_mfma_f32_32x32x16_bf16 v[160:175], a[68:71], v[68:71], v[160:175]
    v_cvt_pk_bf16_f32 v56, v112, v113
    v_cvt_pk_bf16_f32 v57, v114, v115
    v_cvt_pk_bf16_f32 v58, v116, v117
    v_cvt_pk_bf16_f32 v59, v118, v119
    ds_write_b128 v36, v[56:59] offset:64
    s_waitcnt lgkmcnt(5)
    v_mfma_f32_32x32x16_bf16 v[128:143], a[72:75], v[72:75], v[128:143]
    ds_read_b128 v[68:71], v29 offset:256
    v_mfma_f32_32x32x16_bf16 v[144:159], a[76:79], v[72:75], v[144:159]
    v_mfma_f32_32x32x16_bf16 v[160:175], a[80:83], v[72:75], v[160:175]
    v_cvt_pk_bf16_f32 v60, v120, v121
    v_cvt_pk_bf16_f32 v61, v122, v123
    v_cvt_pk_bf16_f32 v62, v124, v125
    v_cvt_pk_bf16_f32 v63, v126, v127
    ds_write_b128 v36, v[60:63] offset:80
    s_waitcnt lgkmcnt(5)
    v_mfma_f32_32x32x16_bf16 v[128:143], a[84:87], v[76:79], v[128:143]
    ds_read_b128 v[72:75], v30 offset:256
    v_mfma_f32_32x32x16_bf16 v[144:159], a[88:91], v[76:79], v[144:159]
    v_mfma_f32_32x32x16_bf16 v[160:175], a[92:95], v[76:79], v[160:175]
    ds_read_b128 v[40:43], v37 offset:0
    s_waitcnt lgkmcnt(5)
    v_mfma_f32_32x32x16_bf16 v[128:143], a[96:99], v[64:67], v[128:143]
    ds_read_b128 v[76:79], v31 offset:256
    v_mfma_f32_32x32x16_bf16 v[144:159], a[100:103], v[64:67], v[144:159]
    v_mfma_f32_32x32x16_bf16 v[160:175], a[104:107], v[64:67], v[160:175]
    ds_read_b128 v[44:47], v37 offset:1024
    s_waitcnt lgkmcnt(5)
    v_mfma_f32_32x32x16_bf16 v[128:143], a[108:111], v[68:71], v[128:143]
    ds_read_b128 v[64:67], v32 offset:256
    v_mfma_f32_32x32x16_bf16 v[144:159], a[112:115], v[68:71], v[144:159]
    v_mfma_f32_32x32x16_bf16 v[160:175], a[116:119], v[68:71], v[160:175]
    ds_read_b128 v[48:51], v37 offset:2048
    s_waitcnt lgkmcnt(5)
    v_mfma_f32_32x32x16_bf16 v[128:143], a[120:123], v[72:75], v[128:143]
    ds_read_b128 v[68:71], v33 offset:256
    v_mfma_f32_32x32x16_bf16 v[144:159], a[124:127], v[72:75], v[144:159]
    v_mfma_f32_32x32x16_bf16 v[160:175], a[128:131], v[72:75], v[160:175]
    ds_read_b128 v[52:55], v37 offset:3072
    s_waitcnt lgkmcnt(5)
    v_mfma_f32_32x32x16_bf16 v[128:143], a[132:135], v[76:79], v[128:143]
    ds_read_b128 v[72:75], v34 offset:256
    v_mfma_f32_32x32x16_bf16 v[144:159], a[136:139], v[76:79], v[144:159]
    v_mfma_f32_32x32x16_bf16 v[160:175], a[140:143], v[76:79], v[160:175]
    ds_read_b128 v[56:59], v37 offset:4096
    s_waitcnt lgkmcnt(5)
    v_mfma_f32_32x32x16_bf16 v[128:143], a[144:147], v[64:67], v[128:143]
    ds_read_b128 v[76:79], v35 offset:256
    v_mfma_f32_32x32x16_bf16 v[144:159], a[148:151], v[64:67], v[144:159]
    v_mfma_f32_32x32x16_bf16 v[160:175], a[152:155], v[64:67], v[160:175]
    ds_read_b128 v[60:63], v37 offset:5120
    s_waitcnt lgkmcnt(5)
    v_mfma_f32_32x32x16_bf16 v[128:143], a[156:159], v[68:71], v[128:143]
    ds_read_b128 v[64:67], v28 offset:512
    v_mfma_f32_32x32x16_bf16 v[144:159], a[160:163], v[68:71], v[144:159]
    v_mfma_f32_32x32x16_bf16 v[160:175], a[164:167], v[68:71], v[160:175]
    s_add_u32 s32, s25, 147456
    s_waitcnt lgkmcnt(11)
    buffer_store_dwordx4 v[40:43], v14, s[20:23], s32 offen nt
    s_waitcnt lgkmcnt(4)
    v_mfma_f32_32x32x16_bf16 v[128:143], a[168:171], v[72:75], v[128:143]
    ds_read_b128 v[68:71], v29 offset:512
    v_mfma_f32_32x32x16_bf16 v[144:159], a[172:175], v[72:75], v[144:159]
    v_mfma_f32_32x32x16_bf16 v[160:175], a[176:179], v[72:75], v[160:175]
    s_waitcnt lgkmcnt(10)
    buffer_store_dwordx4 v[44:47], v15, s[20:23], s32 offen nt
    s_waitcnt lgkmcnt(3)
    v_mfma_f32_32x32x16_bf16 v[128:143], a[180:183], v[76:79], v[128:143]
    ds_read_b128 v[72:75], v30 offset:512
    v_mfma_f32_32x32x16_bf16 v[144:159], a[184:187], v[76:79], v[144:159]
    v_mfma_f32_32x32x16_bf16 v[160:175], a[188:191], v[76:79], v[160:175]
    s_waitcnt lgkmcnt(9)
    buffer_store_dwordx4 v[48:51], v16, s[20:23], s32 offen nt
    s_waitcnt lgkmcnt(2)
    v_mfma_f32_32x32x16_bf16 v[128:143], a[192:195], v[64:67], v[128:143]
    ds_read_b128 v[76:79], v31 offset:512
    v_mfma_f32_32x32x16_bf16 v[144:159], a[196:199], v[64:67], v[144:159]
    v_mfma_f32_32x32x16_bf16 v[160:175], a[200:203], v[64:67], v[160:175]
    s_waitcnt lgkmcnt(8)
    buffer_store_dwordx4 v[52:55], v17, s[20:23], s32 offen nt
    s_waitcnt lgkmcnt(2)
    v_mfma_f32_32x32x16_bf16 v[128:143], a[204:207], v[68:71], v[128:143]
    ds_read_b128 v[64:67], v32 offset:512
    v_mfma_f32_32x32x16_bf16 v[144:159], a[208:211], v[68:71], v[144:159]
    v_mfma_f32_32x32x16_bf16 v[160:175], a[212:215], v[68:71], v[160:175]
    s_waitcnt lgkmcnt(7)
    buffer_store_dwordx4 v[56:59], v18, s[20:23], s32 offen nt
    s_waitcnt lgkmcnt(2)
    v_mfma_f32_32x32x16_bf16 v[128:143], a[216:219], v[72:75], v[128:143]
    ds_read_b128 v[68:71], v33 offset:512
    v_mfma_f32_32x32x16_bf16 v[144:159], a[220:223], v[72:75], v[144:159]
    v_mfma_f32_32x32x16_bf16 v[160:175], a[224:227], v[72:75], v[160:175]
    s_waitcnt lgkmcnt(6)
    buffer_store_dwordx4 v[60:63], v19, s[20:23], s32 offen nt
    s_waitcnt lgkmcnt(2)
    v_mfma_f32_32x32x16_bf16 v[128:143], a[228:231], v[76:79], v[128:143]
    ds_read_b128 v[72:75], v34 offset:512
    v_mfma_f32_32x32x16_bf16 v[144:159], a[232:235], v[76:79], v[144:159]
    v_mfma_f32_32x32x16_bf16 v[160:175], a[236:239], v[76:79], v[160:175]
    s_waitcnt lgkmcnt(2)
    v_mfma_f32_32x32x16_bf16 v[128:143], a[240:243], v[64:67], v[128:143]
    ds_read_b128 v[76:79], v35 offset:512
    v_mfma_f32_32x32x16_bf16 v[144:159], a[244:247], v[64:67], v[144:159]
    v_mfma_f32_32x32x16_bf16 v[160:175], a[248:251], v[64:67], v[160:175]
    s_waitcnt lgkmcnt(2)
    v_mfma_f32_32x32x16_bf16 v[128:143], a[252:255], v[68:71], v[128:143]
    v_mfma_f32_32x32x16_bf16 v[144:159], v[224:227], v[68:71], v[144:159]
    v_mfma_f32_32x32x16_bf16 v[160:175], v[228:231], v[68:71], v[160:175]
    s_waitcnt lgkmcnt(1)
    v_mfma_f32_32x32x16_bf16 v[128:143], v[232:235], v[72:75], v[128:143]
    v_mfma_f32_32x32x16_bf16 v[144:159], v[236:239], v[72:75], v[144:159]
    v_mfma_f32_32x32x16_bf16 v[160:175], v[240:243], v[72:75], v[160:175]
    s_waitcnt lgkmcnt(0)
    v_mfma_f32_32x32x16_bf16 v[128:143], v[244:247], v[76:79], v[128:143]
    v_mfma_f32_32x32x16_bf16 v[144:159], v[248:251], v[76:79], v[144:159]
    v_mfma_f32_32x32x16_bf16 v[160:175], v[252:255], v[76:79], v[160:175]
    s_nop 15
    v_cvt_pk_bf16_f32 v40, v128, v129
    v_cvt_pk_bf16_f32 v41, v130, v131
    v_cvt_pk_bf16_f32 v42, v132, v133
    v_cvt_pk_bf16_f32 v43, v134, v135
    ds_write_b128 v36, v[40:43] offset:0
    v_cvt_pk_bf16_f32 v44, v136, v137
    v_cvt_pk_bf16_f32 v45, v138, v139
    v_cvt_pk_bf16_f32 v46, v140, v141
    v_cvt_pk_bf16_f32 v47, v142, v143
    ds_write_b128 v36, v[44:47] offset:16
    v_cvt_pk_bf16_f32 v48, v144, v145
    v_cvt_pk_bf16_f32 v49, v146, v147
    v_cvt_pk_bf16_f32 v50, v148, v149
    v_cvt_pk_bf16_f32 v51, v150, v151
    ds_write_b128 v36, v[48:51] offset:32
    v_cvt_pk_bf16_f32 v52, v152, v153
    v_cvt_pk_bf16_f32 v53, v154, v155
    v_cvt_pk_bf16_f32 v54, v156, v157
    v_cvt_pk_bf16_f32 v55, v158, v159
    ds_write_b128 v36, v[52:55] offset:48
    v_cvt_pk_bf16_f32 v56, v160, v161
    v_cvt_pk_bf16_f32 v57, v162, v163
    v_cvt_pk_bf16_f32 v58, v164, v165
    v_cvt_pk_bf16_f32 v59, v166, v167
    ds_write_b128 v36, v[56:59] offset:64
    v_cvt_pk_bf16_f32 v60, v168, v169
    v_cvt_pk_bf16_f32 v61, v170, v171
    v_cvt_pk_bf16_f32 v62, v172, v173
    v_cvt_pk_bf16_f32 v63, v174, v175
    ds_write_b128 v36, v[60:63] offset:80
    ds_read_b128 v[40:43], v37 offset:0
    ds_read_b128 v[44:47], v37 offset:1024
    ds_read_b128 v[48:51], v37 offset:2048
    ds_read_b128 v[52:55], v37 offset:3072
    ds_read_b128 v[56:59], v37 offset:4096
    ds_read_b128 v[60:63], v37 offset:5120
    s_add_u32 s32, s25, 172032
    s_waitcnt lgkmcnt(5)
    buffer_store_dwordx4 v[40:43], v14, s[20:23], s32 offen nt
    s_waitcnt lgkmcnt(4)
    buffer_store_dwordx4 v[44:47], v15, s[20:23], s32 offen nt
    s_waitcnt lgkmcnt(3)
    buffer_store_dwordx4 v[48:51], v16, s[20:23], s32 offen nt
    s_waitcnt lgkmcnt(2)
    buffer_store_dwordx4 v[52:55], v17, s[20:23], s32 offen nt
    s_waitcnt lgkmcnt(1)
    buffer_store_dwordx4 v[56:59], v18, s[20:23], s32 offen nt
    s_waitcnt lgkmcnt(0)
    buffer_store_dwordx4 v[60:63], v19, s[20:23], s32 offen nt
L_end:
    s_endpgm
.section .rodata,"a"
.p2align 6
.amdhsa_kernel standalone__standard_2d_1d_3d_conv__vision_kernel
  .amdhsa_next_free_vgpr 512
  .amdhsa_next_free_sgpr 64
  .amdhsa_accum_offset 256
  .amdhsa_group_segment_fixed_size 0
  .amdhsa_kernarg_size 48
  .amdhsa_user_sgpr_count 2
  .amdhsa_user_sgpr_kernarg_segment_ptr 1
  .amdhsa_system_sgpr_workgroup_id_x 1
.end_amdhsa_kernel
```
